```python
import torch

def _softmax(x, axis=-1):
    return torch.softmax(x, dim=axis)
def _gelu(x):
    return torch.nn.functional.gelu(x, approximate="tanh")
def _silu(x):
    return torch.nn.functional.silu(x)
def _sigmoid(x):
    return torch.sigmoid(x)
def _layernorm(x, axis=-1, eps=1e-5):
    m = x.mean(dim=axis, keepdim=True)
    v = x.var(dim=axis, keepdim=True, unbiased=False)
    return (x - m) / torch.sqrt(v + eps)
def _scatter_add(tgt, idx, src, axis=0):
    return tgt.clone().index_add_(axis, idx, src)
def _segment_sum(src, seg, n):
    out = torch.zeros((n,) + src.shape[1:], dtype=src.dtype)
    return out.index_add_(0, seg, src)
def _pad(x, pw):
    flat = tuple(v for pair in reversed(pw) for v in pair)
    return torch.nn.functional.pad(x, flat)

kernel_name = 'standalone__deformable_dcnv1__vision'

def setup_inputs():

    _w = (lambda a: (lambda t: t.to(torch.bfloat16) if t.is_floating_point() else t)(torch.as_tensor(a)))
    H = W = 224
    C = 96
    K = 5
    return {
        "x": _w((lambda *s: torch.randn(*s, dtype=torch.bfloat16) * 0.05)(1, H, W, C)),
        "offset": _w((lambda *s: torch.randn(*s, dtype=torch.bfloat16) * 0.05)(1, H, W, 2 * K * K) * 0.5),
        "w": _w((lambda *s: torch.randn(*s, dtype=torch.bfloat16) * 0.05)(K, K, C, C) * (K * K * C) ** -0.5),
    }

def reference(x, offset, w):
    B, H, W, C = x.shape
    K = 5
    hh = (lambda x, dt: x.to(dt))(torch.arange(H), x.dtype).reshape(1, H, 1)
    ww = (lambda x, dt: x.to(dt))(torch.arange(W), x.dtype).reshape(1, 1, W)
    xf = x.reshape(B, H * W, C)
    def _gather(yi, xi):
        lin = (yi * W + xi).reshape(B, H * W)
        idx = (lambda x, n, axis: torch.repeat_interleave(x, n, dim=axis))(lin[..., None], C, axis=-1)
        return (lambda x, i, axis: torch.take_along_dim(x, i, dim=axis))(xf, idx, axis=1).reshape(B, H, W, C)
    taps = []
    for ki in range(K):
        for kj in range(K):
            t = ki * K + kj
            dy = offset[..., 2 * t]
            dx = offset[..., 2 * t + 1]
            py = torch.clip(hh + (ki - 0.5 * (K - 1)) + dy, 0.0, H - 1.0)
            px = torch.clip(ww + (kj - 0.5 * (K - 1)) + dx, 0.0, W - 1.0)
            y0 = torch.floor(py)
            x0 = torch.floor(px)
            y1 = torch.clip(y0 + 1.0, 0.0, H - 1.0)
            x1 = torch.clip(x0 + 1.0, 0.0, W - 1.0)
            wy = (py - y0)[..., None]
            wx = (px - x0)[..., None]
            y0i = (lambda x, dt: x.to(dt))(y0, torch.int64)
            y1i = (lambda x, dt: x.to(dt))(y1, torch.int64)
            x0i = (lambda x, dt: x.to(dt))(x0, torch.int64)
            x1i = (lambda x, dt: x.to(dt))(x1, torch.int64)
            v = (1 - wy) * (1 - wx) * _gather(y0i, x0i) + (1 - wy) * wx * _gather(y0i, x1i) + wy * (1 - wx) * _gather(y1i, x0i) + wy * wx * _gather(y1i, x1i)
            taps.append(v)
    samp = torch.stack(taps, 3)
    return torch.einsum("bhwkc,kco->bhwo", samp, w.reshape(K * K, C, C))
```

```asm
; @launch grid=(256,1,1) block=(768,1,1) lds=163840
.amdgcn_target "amdgcn-amd-amdhsa--gfx950"
.text
.globl standalone__deformable_dcnv1__vision_kernel
.p2align 12
.p2align 8
.type standalone__deformable_dcnv1__vision_kernel,@function
standalone__deformable_dcnv1__vision_kernel:
    s_load_dwordx8 s[88:95], s[0:1], 0
    s_and_b32 s3, s2, 7
    v_lshrrev_b32 v1, 6, v0
    s_mul_i32 s36, s3, 7
    s_lshr_b32 s39, s2, 3
    s_mov_b32 s40, 168562688
    s_mov_b32 s41, 1909564037
    v_readfirstlane_b32 s20, v1
    s_lshr_b64 s[40:41], s[40:41], s36
    s_lshl_b32 s3, s3, 5
    s_and_b32 s36, s40, 127
    s_bfe_u32 s40, s40, 0x70007
    s_cmp_gt_u32 s39, 31
    s_cbranch_scc1 L_end
    s_add_u32 s36, s36, s39
    s_add_u32 s3, s3, s39
    v_and_b32 v0, 63, v0
    s_getpc_b64 s[100:101]
L_pc:
    s_mul_i32 s37, s39, 12
    v_mul_u32_u24 v83, 384, v0
    s_add_u32 s37, s37, s20
    v_add_lshl_u32 v83, v83, s37, 6
    v_min_u32 v83, L_last-L_pc, v83
    global_load_dword v83, v83, s[100:101]
    s_and_b32 s21, s20, 3
    s_lshr_b32 s29, s20, 2
    s_sub_u32 s37, s3, s40
    s_cmp_lt_u32 s36, s40
    s_cselect_b32 s3, 0, 1
    s_cbranch_scc0 L_qd
    s_cmpk_ge_u32 s36, 61
    s_cbranch_scc1 L_c2
    s_mov_b32 s38, 1055781
    s_cmpk_ge_u32 s36, 12
    s_cselect_b32 s38, 1052516, s38
    s_cmpk_ge_u32 s36, 24
    s_cselect_b32 s38, 67149848, s38
    s_cmpk_ge_u32 s36, 26
    s_cselect_b32 s38, 134232090, s38
    s_cmpk_ge_u32 s36, 29
    s_cselect_b32 s38, 201376788, s38
    s_cmpk_ge_u32 s36, 32
    s_cselect_b32 s38, 134225930, s38
    s_cmpk_ge_u32 s36, 48
    s_cselect_b32 s38, 201327636, s38
    s_branch L_c3
L_c2:
    s_mov_b32 s38, 234935333
    s_cmpk_ge_u32 s36, 74
    s_cselect_b32 s38, 67165192, s38
    s_cmpk_ge_u32 s36, 79
    s_cselect_b32 s38, 6154, s38
    s_cmpk_ge_u32 s36, 80
    s_cselect_b32 s38, 1112874, s38
    s_cmpk_ge_u32 s36, 92
    s_cselect_b32 s38, 1049194, s38
    s_cmpk_ge_u32 s36, 104
    s_cselect_b32 s38, 134242314, s38
    s_cmpk_ge_u32 s36, 112
    s_cselect_b32 s38, 8, s38
L_c3:
    s_lshr_b32 s37, s38, 16
    s_mul_i32 s37, s37, s36
    s_add_u32 s38, s38, s37
L_sp:
    s_bfe_u32 s22, s38, 0x80008
    s_and_b32 s23, s38, 0xf0
    s_cmp_eq_u32 s29, 1
    s_cbranch_scc1 L_as
    s_and_b32 s24, s38, 7
    s_bfe_u32 s27, s38, 0x10003
    s_lshl1_add_u32 s24, s24, 4
    s_sub_u32 s37, s23, 16
    s_cmp_le_u32 s37, 16
    s_cselect_b32 s31, 21, 20
    s_add_u32 s35, s22, s24
    s_sub_u32 s26, s23, s31
    s_add_i32 s26, s26, 18
    s_max_i32 s26, s26, 0
    s_sub_u32 s37, s22, 3
    s_cmp_le_u32 s37, 31
    s_subb_u32 s25, s22, 2
    s_max_i32 s25, s25, 0
    s_cmp_le_u32 s35, 31
    s_addc_u32 s30, s35, 1
    s_min_u32 s30, s30, 223
    s_sub_u32 s30, s30, s25
    s_mul_i32 s28, s31, 192
    s_lshl_b32 s37, s31, 8
    s_sub_u32 s37, s37, 1152
    s_cmp_lg_u32 s27, 0
    s_cselect_b32 s28, s37, s28
    s_branch L_xa
L_qd:
    s_mul_i32 s36, s37, 5958
    s_lshr_b32 s36, s36, 16
    s_mul_i32 s38, s36, 11
    s_mul_i32 s36, s36, 14
    s_sub_u32 s37, s37, s38
    s_add_u32 s22, s36, 42
    s_lshl4_add_u32 s23, s37, 48
    s_add_u32 s25, s36, 40
    s_sub_u32 s26, s23, 2
    s_movk_i32 s28, 3840
    s_mov_b32 s31, 20
    s_add_u32 s35, s36, 56
    s_mov_b32 s24, 14
    s_mov_b32 s27, 0
    s_cmp_eq_u32 s35, 224
    s_cselect_b32 s30, 15, 17
    s_cmp_eq_u32 s29, 1
    s_cbranch_scc1 L_aq
L_xa:
    s_cmp_eq_u32 s29, 0
    s_cbranch_scc1 L_main
    v_lshl_add_u32 v2, s21, 6, v0
    v_mul_u32_u24 v3, 171, v2
    v_lshrrev_b32 v3, 11, v3
    v_mul_u32_u24 v4, 12, v3
    v_sub_u32 v4, v2, v4
    v_add_u32 v3, s26, v3
    s_lshl_b32 s51, s21, 10
    v_lshrrev_b32 v5, 1, v3
    s_mul_i32 s50, s25, 43008
    s_add_u32 s51, s51, 57856
    v_and_b32 v5, 2, v5
    s_mul_i32 s55, s31, 12
    v_xor_b32 v4, v4, v5
    s_mov_b32 m0, s51
    v_mul_u32_u24 v3, 192, v3
    v_cmp_gt_u32 s[52:53], s55, v2
    v_lshl_add_u32 v20, v4, 4, v3
    s_sub_u32 s55, s35, 2
    s_mul_i32 s55, s55, 43008
    s_mov_b32 s6, 9633792
    s_mov_b32 s7, 0x00020000
    s_add_u32 s74, s50, 301056
    s_min_u32 s74, s74, s55
    s_mov_b64 exec, s[52:53]
    s_waitcnt lgkmcnt(0)
    s_and_b32 s5, s89, 0xffff
    s_cmp_lg_u32 s3, 0
    s_mov_b32 s4, s88
    s_cbranch_scc1 L_xlb
    s_barrier
L_xlb:
    buffer_load_dwordx4 v20, s[4:7], s50 offen nt lds
    s_add_u32 m0, m0, s28
    s_add_u32 s50, s50, 43008
    s_cmp_le_u32 s50, s74
    s_cbranch_scc1 L_xlb
    s_mov_b64 exec, -1
    s_cmp_eq_u32 s3, 0
    s_cbranch_scc1 L_fixg
    s_barrier
    s_branch L_fix
L_as:
    s_setprio 3
    v_lshlrev_b32 v57, 4, v0
    v_mov_b32 v35, 0
    s_mul_i32 s78, s21, 22400
    s_mul_i32 s81, s21, 6400
    s_sub_u32 s72, 155200, s78
    s_add_u32 s81, s81, 20992
    s_lshr_b32 s80, s21, 1
    s_sub_u32 s73, 246400, s78
    s_mul_i32 s80, s80, 22400
    s_mov_b32 m0, s81
    s_mov_b32 s10, 5017600
    s_mov_b32 s11, 0x00020000
    s_mul_i32 s36, s22, 22400
    s_mul_i32 s37, s23, 100
    s_add_u32 s36, s36, s37
    s_add_u32 s78, s78, s36
    s_add_u32 s72, s72, s36
    s_waitcnt lgkmcnt(0)
    ds_write_b32 v35, v35 offset:272
    s_mov_b32 s8, s90
    s_and_b32 s9, s91, 0xffff
    buffer_load_dwordx4 v57, s[8:11], s78 offen nt lds
    buffer_load_dwordx4 v57, s[8:11], s72 offen offset:1600 nt lds
    s_mov_b32 exec_hi, 15
    s_and_b32 s37, s38, 7
    buffer_load_dwordx4 v57, s[8:11], s78 offen offset:1024 nt lds
    buffer_load_dwordx4 v57, s[8:11], s72 offen offset:2624 nt lds
    s_cmp_lt_u32 s37, 3
    s_cbranch_scc1 L_a1
    s_add_u32 s73, s73, s36
    s_add_u32 s80, s80, s36
    s_add_u32 m0, s81, 3200
    s_add_u32 s80, s80, 267200
    s_cmp_eq_u32 s37, 5
    s_cselect_b32 s80, s80, 0x40000000
    buffer_load_dwordx4 v57, s[8:11], s73 offen offset:1024 nt lds
    buffer_load_dwordx4 v57, s[8:11], s80 offen offset:2624 nt lds
    s_mov_b32 exec_hi, -1
    buffer_load_dwordx4 v57, s[8:11], s73 offen nt lds
    buffer_load_dwordx4 v57, s[8:11], s80 offen offset:1600 nt lds
L_a1:
    s_mov_b32 exec_hi, -1
    s_waitcnt lgkmcnt(0)
    s_barrier
    s_and_b32 s24, s38, 7
    s_bfe_u32 s27, s38, 0x10003
    s_lshl1_add_u32 s24, s24, 4
    s_sub_u32 s37, s23, 16
    s_cmp_le_u32 s37, 16
    s_cselect_b32 s31, 21, 20
    s_add_u32 s35, s22, s24
    s_sub_u32 s26, s23, s31
    s_add_i32 s26, s26, 18
    s_max_i32 s26, s26, 0
    s_sub_u32 s37, s22, 3
    s_cmp_le_u32 s37, 31
    s_subb_u32 s25, s22, 2
    s_max_i32 s25, s25, 0
    s_cmp_le_u32 s35, 31
    s_addc_u32 s30, s35, 1
    s_min_u32 s30, s30, 223
    s_sub_u32 s30, s30, s25
    s_mul_i32 s28, s31, 192
    s_lshl_b32 s37, s31, 8
    s_sub_u32 s37, s37, 1152
    s_cmp_lg_u32 s27, 0
    s_cselect_b32 s28, s37, s28
    s_branch L_A2
L_aq:
    s_setprio 3
    v_lshlrev_b32 v57, 4, v0
L_A2:
    s_mov_b32 s14, 460800
    s_mov_b32 s15, 0x00020000
    s_mul_i32 s61, s21, 4608
    s_lshl_b32 s72, s21, 5
    s_and_b32 s73, s72, 32
    v_add_u32 v58, s61, v57
    s_add_u32 s61, s61, 2560
    v_xor_b32 v58, s73, v58
    s_mov_b32 s60, 0
    v_xor_b32 v59, 32, v58
    s_mov_b32 m0, s61
    s_lshl2_add_u32 s72, s39, s21
    s_lshl_b32 s72, s72, 10
    s_mov_b32 vcc_lo, 0
    s_mov_b32 vcc_hi, 4294901760
    v_cndmask_b32 v105, v58, v59, vcc
    s_mov_b32 vcc_lo, 4294901760
    s_mov_b32 vcc_hi, 4294967295
    v_cndmask_b32 v106, v58, v59, vcc
    s_mov_b32 vcc_lo, 4294967295
    s_mov_b32 vcc_hi, 65535
    v_cndmask_b32 v107, v58, v59, vcc
    s_mov_b32 vcc_lo, 0
    s_mov_b32 vcc_hi, 0
    v_cndmask_b32 v108, v58, v59, vcc
    s_mov_b32 vcc_lo, 4294901760
    s_mov_b32 vcc_hi, 4294967295
    v_cndmask_b32 v109, v58, v59, vcc
    s_waitcnt lgkmcnt(0)
    s_and_b32 s13, s93, 0xffff
    s_mov_b32 s12, s92
    s_cmp_eq_u32 s3, 0
    buffer_load_dwordx4 v[132:135], v57, s[12:15], s72 offen
    s_cbranch_scc1 L_a2
    s_lshr_b32 s80, s21, 1
    s_mul_i32 s29, s21, 0x100ff
    s_add_u32 s80, s80, 12
    s_sub_u32 s29, 0x000b0700, s29
    s_lshl_b32 s80, s80, 24
    v_lshrrev_b32 v64, 4, v0
    v_and_b32 v65, 15, v0
    s_or_b32 s29, s29, s80
    v_lshlrev_b32 v66, 3, v64
    v_bfe_u32 v66, s29, v66, 8
    s_lshl_b32 s29, s21, 9
    v_add_u32 v13, s25, v66
    s_add_u32 s29, s29, 512
    v_mov_b32 v16, 3840
    v_lshl_add_u32 v69, v65, 4, s29
    s_mul_i32 s72, s25, 3840
    v_lshl_add_u32 v14, v64, 2, v69
    s_mul_i32 s73, s26, 192
    v_mul_u32_u24 v12, v13, v16
    s_sub_u32 s72, 57856, s72
    v_mov_b32 v15, 192
    s_sub_u32 s72, s72, s73
    v_add_u32 v65, s26, v65
    s_movk_i32 s77, 223
    v_mov_b32 v35, 0
    v_add_u32 v70, 0, v65
    s_mov_b32 s55, 0
    v_min_u32 v70, s77, v70
    s_mov_b32 s56, 0
    v_mad_u32_u24 v7, v70, v15, s72
    v_lshlrev_b32 v70, 3, v70
    v_and_or_b32 v7, v70, 32, v7
    v_add_u32 v70, 1, v65
    s_mov_b32 s57, 27
    v_min_u32 v70, s77, v70
    s_mov_b32 s58, 0
    v_mad_u32_u24 v8, v70, v15, s72
    v_lshlrev_b32 v70, 3, v70
    v_and_or_b32 v8, v70, 32, v8
    v_add_u32 v70, 2, v65
    s_mov_b32 s59, 0
    v_min_u32 v70, s77, v70
    s_mov_b32 s62, 0
    v_mad_u32_u24 v9, v70, v15, s72
    v_lshlrev_b32 v70, 3, v70
    v_and_or_b32 v9, v70, 32, v9
    v_add_u32 v70, 3, v65
    s_mov_b32 s40, 0
    v_min_u32 v70, s77, v70
    s_mov_b32 s82, 4294930432
    v_mad_u32_u24 v10, v70, v15, s72
    v_lshlrev_b32 v70, 3, v70
    v_and_or_b32 v10, v70, 32, v10
    v_add_u32 v70, 4, v65
    s_mov_b32 s83, 18432
    v_min_u32 v70, s77, v70
    s_mov_b32 s36, 67076103
    v_mad_u32_u24 v11, v70, v15, s72
    v_lshlrev_b32 v70, 3, v70
    v_and_or_b32 v11, v70, 32, v11
    s_mov_b32 s37, 67076103
    s_barrier
    buffer_load_dwordx4 v105, s[12:15], s60 offen lds
    buffer_load_dwordx4 v106, s[12:15], s60 offen offset:512 lds
    buffer_load_dwordx4 v107, s[12:15], s60 offen offset:1536 lds
    buffer_load_dwordx4 v108, s[12:15], s60 offen offset:2560 lds
    buffer_load_dwordx4 v109, s[12:15], s60 offen offset:3584 lds
    s_add_u32 m0, m0, 18432
    s_add_u32 s60, s60, 18432
    buffer_load_dwordx4 v105, s[12:15], s60 offen lds
    buffer_load_dwordx4 v106, s[12:15], s60 offen offset:512 lds
    buffer_load_dwordx4 v107, s[12:15], s60 offen offset:1536 lds
    buffer_load_dwordx4 v108, s[12:15], s60 offen offset:2560 lds
    buffer_load_dwordx4 v109, s[12:15], s60 offen offset:3584 lds
    s_branch L_fast
L_a2:
    s_add_u32 s29, s30, 1
    s_mul_i32 s34, s29, s28
    s_lshl_b32 s29, s27, 13
    s_add_u32 s34, s34, 57856
    s_sub_u32 s32, 163056, s29
    s_sub_u32 s32, s32, s34
    s_lshr_b32 s80, s21, 1
    s_add_u32 s80, s80, 12
    s_lshl_b32 s80, s80, 24
    v_lshrrev_b32 v64, 4, v0
    v_and_b32 v65, 15, v0
    s_mul_i32 s29, s21, 0x100ff
    s_sub_u32 s29, 0x000b0700, s29
    s_or_b32 s29, s29, s80
    v_lshlrev_b32 v66, 3, v64
    v_bfe_u32 v66, s29, v66, 8
    v_mul_u32_u24 v22, 1600, v64
    v_cmp_gt_u32 s[42:43], s24, v66
    v_mul_u32_u24 v68, 100, v65
    s_mul_i32 s72, s22, 22400
    s_mul_i32 s73, s23, 100
    v_add3_u32 v22, v22, v68, s81
    s_add_u32 s72, s72, s73
    v_mul_u32_u24 v141, 22400, v66
    v_mov_b32 v142, 99
    v_add3_u32 v141, v141, v68, s72
    v_add_u32 v13, s22, v66
    v_add_u32 v46, s23, v65
    s_lshl_b32 s29, s21, 9
    s_add_u32 s29, s29, 512
    v_lshl_add_u32 v69, v65, 4, s29
    v_lshl_add_u32 v14, v64, 2, v69
    v_mov_b32 v34, 0
    s_lshl_b32 s70, s21, 10
    s_add_u32 s70, s70, 159744
    s_add_u32 s71, s70, 512
    s_xor_b32 s71, s71, s70
    s_lshl_b32 s29, s21, 2
    s_add_u32 s29, s29, 256
    v_mov_b32 v128, s29
    v_add_u32 v45, 32, v128
    v_mov_b32 v18, 196
    v_mov_b32 v70, 192
    v_mov_b32 v71, s28
    v_cndmask_b32 v15, 0, v70, s[42:43]
    v_cndmask_b32 v16, 0, v71, s[42:43]
    s_mul_i32 s72, s25, s28
    s_mul_i32 s73, s26, 192
    s_sub_u32 s72, 57856, s72
    s_sub_u32 s72, s72, s73
    v_mov_b32 v70, s72
    v_cndmask_b32 v17, 0, v70, s[42:43]
    s_movk_i32 s77, 223
    v_add_u32 v13, -2, v13
    v_add_u32 v125, -2, v46
    v_mov_b32 v124, v13
    v_cvt_f32_i32 v1, v13
    v_cvt_f32_i32 v127, v125
    v_med3_i32 v12, v13, 0, s77
    v_mul_u32_u24 v12, v12, v16
    s_mov_b32 s72, 0x04010401
    s_movk_i32 s73, 257
    v_add_u32 v24, 0, v125
    v_add_u32 v70, 0, v124
    v_min_u32 v71, s73, v24
    v_min_u32 v70, s73, v70
    v_med3_i32 v24, v24, 0, s77
    v_cvt_f32_u32 v71, v71
    v_cvt_f32_u32 v70, v70
    v_mad_u32_u24 v7, v24, v15, v17
    v_add_f32 v71, -0.5, v71
    v_add_f32 v70, -0.5, v70
    v_lshlrev_b32 v72, 3, v24
    v_cvt_pk_bf16_f32 v70, v70, v71
    v_and_or_b32 v7, v72, 32, v7
    v_pk_max_i16 v70, v70, 0
    v_and_b32 v70, 0x7f807f80, v70
    v_pk_sub_u16 v115, v70, s72 clamp
    v_and_b32 v110, 0xffff, v115
    v_and_b32 v115, 0xffff0000, v115
    v_add_u32 v110, 1, v110
    v_add_u32 v25, 1, v125
    v_add_u32 v70, 1, v124
    v_min_u32 v71, s73, v25
    v_min_u32 v70, s73, v70
    v_med3_i32 v25, v25, 0, s77
    v_cvt_f32_u32 v71, v71
    v_cvt_f32_u32 v70, v70
    v_mad_u32_u24 v8, v25, v15, v17
    v_add_f32 v71, -0.5, v71
    v_add_f32 v70, -0.5, v70
    v_lshlrev_b32 v72, 3, v25
    v_cvt_pk_bf16_f32 v70, v70, v71
    v_and_or_b32 v8, v72, 32, v8
    v_pk_max_i16 v70, v70, 0
    v_and_b32 v70, 0x7f807f80, v70
    v_pk_sub_u16 v116, v70, s72 clamp
    v_and_b32 v111, 0xffff, v116
    v_and_b32 v116, 0xffff0000, v116
    v_add_u32 v111, 1, v111
    v_add_u32 v26, 2, v125
    v_add_u32 v70, 2, v124
    v_min_u32 v71, s73, v26
    v_min_u32 v70, s73, v70
    v_med3_i32 v26, v26, 0, s77
    v_cvt_f32_u32 v71, v71
    v_cvt_f32_u32 v70, v70
    v_mad_u32_u24 v9, v26, v15, v17
    v_add_f32 v71, -0.5, v71
    v_add_f32 v70, -0.5, v70
    v_lshlrev_b32 v72, 3, v26
    v_cvt_pk_bf16_f32 v70, v70, v71
    v_and_or_b32 v9, v72, 32, v9
    v_pk_max_i16 v70, v70, 0
    v_and_b32 v70, 0x7f807f80, v70
    v_pk_sub_u16 v117, v70, s72 clamp
    v_and_b32 v112, 0xffff, v117
    v_and_b32 v117, 0xffff0000, v117
    v_add_u32 v112, 1, v112
    v_add_u32 v27, 3, v125
    v_add_u32 v70, 3, v124
    v_min_u32 v71, s73, v27
    v_min_u32 v70, s73, v70
    v_med3_i32 v27, v27, 0, s77
    v_cvt_f32_u32 v71, v71
    v_cvt_f32_u32 v70, v70
    v_mad_u32_u24 v10, v27, v15, v17
    v_add_f32 v71, -0.5, v71
    v_add_f32 v70, -0.5, v70
    v_lshlrev_b32 v72, 3, v27
    v_cvt_pk_bf16_f32 v70, v70, v71
    v_and_or_b32 v10, v72, 32, v10
    v_pk_max_i16 v70, v70, 0
    v_and_b32 v70, 0x7f807f80, v70
    v_pk_sub_u16 v118, v70, s72 clamp
    v_and_b32 v113, 0xffff, v118
    v_and_b32 v118, 0xffff0000, v118
    v_add_u32 v113, 1, v113
    v_add_u32 v28, 4, v125
    v_add_u32 v70, 4, v124
    v_min_u32 v71, s73, v28
    v_min_u32 v70, s73, v70
    v_med3_i32 v28, v28, 0, s77
    v_cvt_f32_u32 v71, v71
    v_cvt_f32_u32 v70, v70
    v_mad_u32_u24 v11, v28, v15, v17
    v_add_f32 v71, -0.5, v71
    v_add_f32 v70, -0.5, v70
    v_lshlrev_b32 v72, 3, v28
    v_cvt_pk_bf16_f32 v70, v70, v71
    v_and_or_b32 v11, v72, 32, v11
    v_pk_max_i16 v70, v70, 0
    v_and_b32 v70, 0x7f807f80, v70
    v_pk_sub_u16 v119, v70, s72 clamp
    v_and_b32 v114, 0xffff, v119
    v_and_b32 v119, 0xffff0000, v119
    v_add_u32 v114, 1, v114
    s_add_u32 s72, s25, s30
    s_add_u32 s73, s26, s31
    v_add_u32 v70, -1, v124
    v_add_u32 v71, 5, v124
    v_max_i32 v70, 0, v70
    v_min_i32 v71, s77, v71
    v_cmp_gt_u32 vcc, s25, v70
    v_cmp_lt_u32 s[50:51], s72, v71
    v_mov_b32 v72, 248
    v_mov_b32 v73, 63488
    v_add_u32 v70, -1, v125
    v_cndmask_b32 v120, 0, v72, vcc
    v_cndmask_b32 v121, 0, v73, s[50:51]
    v_add_u32 v71, 5, v125
    v_max_i32 v70, 0, v70
    v_min_i32 v71, s77, v71
    v_cmp_gt_u32 vcc, s26, v70
    v_cmp_le_u32 s[50:51], s73, v71
    v_or_b32 v72, 554172416, v120
    v_or_b32 v73, 138412032, v121
    v_cndmask_b32 v120, v120, v72, vcc
    v_cndmask_b32 v121, v121, v73, vcc
    v_or_b32 v72, 276824064, v120
    v_or_b32 v73, 2216689664, v121
    v_cndmask_b32 v120, v120, v72, s[50:51]
    v_cndmask_b32 v121, v121, v73, s[50:51]
    v_and_b32 v21, 3, v0
    v_lshlrev_b32 v21, 2, v21
    v_add_u32 v21, 288, v21
    s_mov_b32 s55, 0
    s_mov_b32 s56, 0
    s_mov_b32 s57, 25
    s_mov_b32 s58, 0
    s_mov_b32 s59, 0
    s_mov_b32 s62, 0
    s_mov_b32 s65, 0
    s_mov_b32 s66, 0
    s_mov_b32 s67, 0
    s_mov_b32 s74, 0
    s_mov_b32 s75, 0
    s_mov_b32 s40, 0
    s_mov_b64 s[48:49], 0
    s_mov_b32 s82, 4294930432
    s_mov_b32 s83, 18432
    s_mov_b32 s54, 0x435f435f
    s_mov_b32 s76, 0x0c0c0c00
    v_mov_b32 v19, 0xe0c0c0c0
    v_mov_b32 v20, 0xa0c0c0c0
    s_waitcnt vmcnt(1)
    ds_read2_b32 v[80:81], v22 offset0:0 offset1:1
    ds_read2_b32 v[82:83], v22 offset0:2 offset1:3
    ds_read2_b32 v[84:85], v22 offset0:4 offset1:5
    ds_read2_b32 v[86:87], v22 offset0:6 offset1:7
    ds_read2_b32 v[88:89], v22 offset0:8 offset1:9
    ds_read2_b32 v[90:91], v22 offset0:10 offset1:11
    ds_read2_b32 v[92:93], v22 offset0:12 offset1:13
    ds_read2_b32 v[94:95], v22 offset0:14 offset1:15
    ds_read2_b32 v[96:97], v22 offset0:16 offset1:17
    ds_read2_b32 v[98:99], v22 offset0:18 offset1:19
    ds_read2_b32 v[100:101], v22 offset0:20 offset1:21
    ds_read2_b32 v[102:103], v22 offset0:22 offset1:23
    ds_read_b32 v104, v22 offset:96
    s_bitcmp1_b32 s2, 31
    s_mov_b32 s72, 0x80008000
    v_mov_b32 v122, 0
    v_mov_b32 v123, 0
    v_mov_b32 v62, -1
    s_cbranch_scc1 L_gen
    s_waitcnt lgkmcnt(12)
    v_bitop3_b32 v64, v80, s72, s72 bitop3:0xcf
    v_bitop3_b32 v65, v81, s72, s72 bitop3:0xcf
    s_waitcnt lgkmcnt(11)
    v_bitop3_b32 v66, v82, s72, s72 bitop3:0xcf
    v_bitop3_b32 v67, v83, s72, s72 bitop3:0xcf
    s_waitcnt lgkmcnt(10)
    v_bitop3_b32 v68, v84, s72, s72 bitop3:0xcf
    v_add3_u32 v69, v64, v110, v115
    v_pk_min_u16 v62, v64, v62
    v_add3_u32 v70, v65, v110, v116
    v_pk_min_u16 v62, v65, v62
    v_add3_u32 v71, v66, v110, v117
    v_pk_min_u16 v62, v66, v62
    v_add3_u32 v72, v67, v110, v118
    v_pk_min_u16 v62, v67, v62
    v_add3_u32 v73, v68, v110, v119
    v_pk_min_u16 v62, v68, v62
    v_lshrrev_b32 v122, 1, v122
    v_bfi_b32 v122, s72, v69, v122
    v_lshrrev_b32 v122, 1, v122
    v_bfi_b32 v122, s72, v70, v122
    v_lshrrev_b32 v122, 1, v122
    v_bfi_b32 v122, s72, v71, v122
    v_lshrrev_b32 v122, 1, v122
    v_bfi_b32 v122, s72, v72, v122
    v_lshrrev_b32 v122, 1, v122
    v_bfi_b32 v122, s72, v73, v122
    v_bitop3_b32 v64, v85, s72, s72 bitop3:0xcf
    s_waitcnt lgkmcnt(9)
    v_bitop3_b32 v65, v86, s72, s72 bitop3:0xcf
    v_bitop3_b32 v66, v87, s72, s72 bitop3:0xcf
    s_waitcnt lgkmcnt(8)
    v_bitop3_b32 v67, v88, s72, s72 bitop3:0xcf
    v_bitop3_b32 v68, v89, s72, s72 bitop3:0xcf
    v_add3_u32 v69, v64, v111, v115
    v_pk_min_u16 v62, v64, v62
    v_add3_u32 v70, v65, v111, v116
    v_pk_min_u16 v62, v65, v62
    v_add3_u32 v71, v66, v111, v117
    v_pk_min_u16 v62, v66, v62
    v_add3_u32 v72, v67, v111, v118
    v_pk_min_u16 v62, v67, v62
    v_add3_u32 v73, v68, v111, v119
    v_pk_min_u16 v62, v68, v62
    v_lshrrev_b32 v122, 1, v122
    v_bfi_b32 v122, s72, v69, v122
    v_lshrrev_b32 v122, 1, v122
    v_bfi_b32 v122, s72, v70, v122
    v_lshrrev_b32 v122, 1, v122
    v_bfi_b32 v122, s72, v71, v122
    v_lshrrev_b32 v122, 1, v122
    v_bfi_b32 v122, s72, v72, v122
    v_lshrrev_b32 v122, 1, v122
    v_bfi_b32 v122, s72, v73, v122
    s_waitcnt lgkmcnt(7)
    v_bitop3_b32 v64, v90, s72, s72 bitop3:0xcf
    v_bitop3_b32 v65, v91, s72, s72 bitop3:0xcf
    s_waitcnt lgkmcnt(6)
    v_bitop3_b32 v66, v92, s72, s72 bitop3:0xcf
    v_bitop3_b32 v67, v93, s72, s72 bitop3:0xcf
    s_waitcnt lgkmcnt(5)
    v_bitop3_b32 v68, v94, s72, s72 bitop3:0xcf
    v_add3_u32 v69, v64, v112, v115
    v_pk_min_u16 v62, v64, v62
    v_add3_u32 v70, v65, v112, v116
    v_pk_min_u16 v62, v65, v62
    v_add3_u32 v71, v66, v112, v117
    v_pk_min_u16 v62, v66, v62
    v_add3_u32 v72, v67, v112, v118
    v_pk_min_u16 v62, v67, v62
    v_add3_u32 v73, v68, v112, v119
    v_pk_min_u16 v62, v68, v62
    v_lshrrev_b32 v122, 1, v122
    v_bfi_b32 v122, s72, v69, v122
    v_lshrrev_b32 v122, 1, v122
    v_bfi_b32 v122, s72, v70, v122
    v_lshrrev_b32 v122, 1, v122
    v_bfi_b32 v122, s72, v71, v122
    v_lshrrev_b32 v123, 1, v123
    v_bfi_b32 v123, s72, v72, v123
    v_lshrrev_b32 v123, 1, v123
    v_bfi_b32 v123, s72, v73, v123
    v_bitop3_b32 v64, v95, s72, s72 bitop3:0xcf
    s_waitcnt lgkmcnt(4)
    v_bitop3_b32 v65, v96, s72, s72 bitop3:0xcf
    v_bitop3_b32 v66, v97, s72, s72 bitop3:0xcf
    s_waitcnt lgkmcnt(3)
    v_bitop3_b32 v67, v98, s72, s72 bitop3:0xcf
    v_bitop3_b32 v68, v99, s72, s72 bitop3:0xcf
    v_add3_u32 v69, v64, v113, v115
    v_pk_min_u16 v62, v64, v62
    v_add3_u32 v70, v65, v113, v116
    v_pk_min_u16 v62, v65, v62
    v_add3_u32 v71, v66, v113, v117
    v_pk_min_u16 v62, v66, v62
    v_add3_u32 v72, v67, v113, v118
    v_pk_min_u16 v62, v67, v62
    v_add3_u32 v73, v68, v113, v119
    v_pk_min_u16 v62, v68, v62
    v_lshrrev_b32 v123, 1, v123
    v_bfi_b32 v123, s72, v69, v123
    v_lshrrev_b32 v123, 1, v123
    v_bfi_b32 v123, s72, v70, v123
    v_lshrrev_b32 v123, 1, v123
    v_bfi_b32 v123, s72, v71, v123
    v_lshrrev_b32 v123, 1, v123
    v_bfi_b32 v123, s72, v72, v123
    v_lshrrev_b32 v123, 1, v123
    v_bfi_b32 v123, s72, v73, v123
    s_waitcnt lgkmcnt(2)
    v_bitop3_b32 v64, v100, s72, s72 bitop3:0xcf
    v_bitop3_b32 v65, v101, s72, s72 bitop3:0xcf
    s_waitcnt lgkmcnt(1)
    v_bitop3_b32 v66, v102, s72, s72 bitop3:0xcf
    v_bitop3_b32 v67, v103, s72, s72 bitop3:0xcf
    s_waitcnt lgkmcnt(0)
    v_bitop3_b32 v68, v104, s72, s72 bitop3:0xcf
    v_add3_u32 v69, v64, v114, v115
    v_pk_min_u16 v62, v64, v62
    v_add3_u32 v70, v65, v114, v116
    v_pk_min_u16 v62, v65, v62
    v_add3_u32 v71, v66, v114, v117
    v_pk_min_u16 v62, v66, v62
    v_add3_u32 v72, v67, v114, v118
    v_pk_min_u16 v62, v67, v62
    v_add3_u32 v73, v68, v114, v119
    v_pk_min_u16 v62, v68, v62
    v_lshrrev_b32 v123, 1, v123
    v_bfi_b32 v123, s72, v69, v123
    v_lshrrev_b32 v123, 1, v123
    v_bfi_b32 v123, s72, v70, v123
    v_lshrrev_b32 v123, 1, v123
    v_bfi_b32 v123, s72, v71, v123
    v_lshrrev_b32 v123, 1, v123
    v_bfi_b32 v123, s72, v72, v123
    v_lshrrev_b32 v123, 1, v123
    v_bfi_b32 v123, s72, v73, v123
    s_mov_b32 s73, 3229663360
    v_pk_min_u16 v62, v62, s73
    v_and_b32 v55, v122, v120
    v_lshrrev_b32 v64, 16, v122
    v_lshrrev_b32 v65, 16, v123
    v_and_or_b32 v55, v123, v121, v55
    v_and_b32 v66, v64, v122
    v_and_b32 v67, v65, v123
    v_cmp_ne_u32 vcc, s73, v62
    v_cmp_ne_u32 s[50:51], 0, v55
    v_bcnt_u32_b32 v68, v66, 0
    v_bcnt_u32_b32 v69, v122, 0
    v_bcnt_u32_b32 v68, v67, v68
    v_bcnt_u32_b32 v69, v123, v69
    s_or_b64 vcc, vcc, s[50:51]
    s_cmp_lg_u32 s27, 0
    s_cbranch_scc1 L_mask1
    v_add_u32 v68, v68, v69
    v_bitop3_b32 v66, v64, v122, s72 bitop3:0xfc
    v_bitop3_b32 v67, v65, v123, s72 bitop3:0xfc
    v_and_b32 v66, 0xffff, v66
    v_and_b32 v67, 0xffff, v67
    s_branch L_mask2
L_mask1:
    s_cmp_lt_u32 s24, 5
    s_cselect_b32 s72, 0, 3
    v_mul_u32_u24 v68, s72, v68
L_mask2:
    v_lshrrev_b32 v66, 3, v66
    v_mov_b32 v69, 0x1000
    v_lshl_or_b32 v66, v67, 9, v66
    v_cndmask_b32 v68, v68, v69, vcc
    v_cndmask_b32 v66, 0, v66, s[42:43]
    v_cndmask_b32 v68, 0, v68, s[42:43]
    v_and_b32 v136, -32, v66
    s_mov_b32 s36, 50331649
    v_or_b32_dpp v66, v66, v66 row_shr:1
    v_add_u32_dpp v68, v68, v68 row_shr:1
    s_mov_b32 s37, 50331649
    v_or_b32_dpp v66, v66, v66 row_shr:2
    v_add_u32_dpp v68, v68, v68 row_shr:2
    s_mov_b32 s66, 0
    v_or_b32_dpp v66, v66, v66 row_shr:4
    v_add_u32_dpp v68, v68, v68 row_shr:4
    s_mov_b32 s64, 99
    v_or_b32_dpp v66, v66, v66 row_shr:8
    v_add_u32_dpp v68, v68, v68 row_shr:8
    s_nop 0
    v_or_b32_dpp v66, v66, v66 row_bcast:15 row_mask:0xa
    v_add_u32_dpp v68, v68, v68 row_bcast:15 row_mask:0xa
    s_nop 0
    v_or_b32_dpp v66, v66, v66 row_bcast:31 row_mask:0xc
    v_add_u32_dpp v68, v68, v68 row_bcast:31 row_mask:0xc
    v_mov_b32 v55, 0
    v_readlane_b32 s74, v66, 63
    v_readlane_b32 s63, v68, 63
    s_add_u32 s63, s63, 1
    s_andn2_b32 s63, s63, 1
    s_cbranch_scc0 L_al0
    v_mov_b32 v54, s63
    s_mov_b64 exec, 1
    ds_add_rtn_u32 v55, v35, v54 offset:272
    s_mov_b64 exec, -1
    v_mov_b32 v124, v1
    v_mov_b32 v125, v127
    s_brev_b32 s37, s74
    s_lshr_b32 s37, s37, 6
    s_or_b32 s37, s37, 1
    s_waitcnt lgkmcnt(0)
    v_readfirstlane_b32 s66, v55
    v_lshl_or_b32 v55, v55, 1, 1
    s_add_u32 s72, s66, s63
    s_mul_i32 s72, s72, 196
    s_cmp_gt_u32 s72, s32
    s_cbranch_scc1 L_ovfl
L_al0:
    s_or_b32 s72, s63, s27
    s_mov_b64 exec, 1
    ds_write_b32 v128, v55
    s_mov_b64 exec, -1
    s_cbranch_scc0 L_fast
L_sd:
    s_mov_b32 s36, -1
    s_mov_b32 s65, s66
    s_mov_b32 s40, 2
    s_mov_b32 s75, s74
    s_cmp_eq_u32 s27, 0
    s_cbranch_scc1 L_lsi
    s_cmp_lt_u32 s24, 5
    s_cselect_b32 s40, 4, 3
    s_lshl_b32 s72, s21, 11
    s_add_u32 s72, s72, 155648
    v_mov_b32 v64, 0
    v_mov_b32 v65, 0
    v_mov_b32 v66, 0
    v_mov_b32 v67, 0
    v_lshl_add_u32 v68, v0, 4, s72
    v_bfe_u32 v69, v0, 4, 1
    ds_write_b128 v68, v[64:67]
    ds_write_b128 v68, v[64:67] offset:1024
    v_and_b32 v71, 15, v0
    v_and_b32 v72, 3, v0
    v_lshl_add_u32 v126, v71, 5, s72
    v_lshl_add_u32 v126, v69, 4, v126
    v_lshl_add_u32 v126, v72, 2, v126
    s_lshl_b32 s72, s21, 9
    s_add_u32 s72, s72, 512
    v_and_b32 v70, 12, v0
    v_and_b32 v71, 1, v0
    v_lshl_add_u32 v70, v71, 1, v70
    v_lshl_add_u32 v14, v70, 4, s72
    v_and_b32 v71, 2, v0
    v_lshl_add_u32 v14, v69, 3, v14
    v_lshl_add_u32 v14, v71, 1, v14
    s_movk_i32 s38, 0x600
L_dstep0:
    s_set_gpr_idx_on s56, gpr_idx(SRC1)
    s_nop 0
    v_and_b32 v49, 0xffff0000, v80
    v_lshlrev_b32 v48, 16, v80
    s_set_gpr_idx_off
    s_mov_b32 m0, s61
    s_add_u32 s56, s56, 1
    s_add_u32 s58, s58, 1
    s_sub_u32 s57, s57, 1
    s_mov_b32 s60, s59
    s_add_u32 s59, s59, 18432
    v_add_f32 v49, v127, v49
    v_add_f32 v48, v1, v48
    v_add_f32 v127, 1.0, v127
    v_cvt_pk_bf16_f32 v54, v48, v49
    v_pk_max_i16 v54, v54, 0
    v_pk_min_i16 v54, v54, s54
    v_and_b32 v49, 0xffff0000, v54
    v_lshlrev_b32 v48, 16, v54
    v_cvt_u32_f32 v51, v49
    v_fract_f32 v53, v49
    v_fract_f32 v52, v48
    v_cvt_u32_f32 v50, v48
    v_mad_u32_u24 v32, v51, v15, v17
    v_cmp_lt_f32 vcc, 0, v53
    v_cmp_lt_f32 s[46:47], 0, v52
    v_lshlrev_b32 v54, 3, v51
    v_and_or_b32 v58, v51, 7, s76
    v_add_f32 v57, v52, v53
    v_and_or_b32 v32, v54, 32, v32
    s_or_b64 s[44:45], s[46:47], vcc
    s_and_b64 s[44:45], s[44:45], s[42:43]
    v_perm_b32 v58, v20, v19, v58
    v_mad_u32_u24 v32, v50, v16, v32
    v_sub_f32 v34, 1.0, v57
L_d1:
    s_lshr_b32 s72, s74, s56
    s_cselect_b32 s63, 0, 2
    s_cmp_eq_u32 s40, 4
    s_cbranch_scc1 L_d4
    v_cndmask_b32 v54, v16, v58, vcc
    s_and_b64 s[52:53], s[46:47], vcc
    v_cvt_pk_bf16_f32 v34, v34, v57
    v_cndmask_b32 v54, 0, v54, s[44:45]
    s_and_b64 s[52:53], s[52:53], s[42:43]
    v_add_u32 v33, v32, v54
    s_cbranch_scc1 L_d2p
L_d2:
    v_or_b32 v32, s63, v32
    s_mov_b32 exec_hi, 0
    ds_write_b32 v126, v34
    ds_write2_b32 v14, v32, v33 offset0:0 offset1:4
L_d3:
    s_mov_b64 exec, -1
    v_add_u32 v54, 0x200, v126
    s_cmp_lt_u32 s55, 2
    v_bfi_b32 v126, s38, v54, v126
    s_cbranch_scc0 L_wr3H
L_early:
    v_xor_b32 v14, 0x100, v14
    s_xor_b32 s70, s70, s71
    s_sub_u32 s68, s69, s68
    s_add_u32 s62, s62, 1
    s_add_u32 s55, s55, 1
    s_cmp_eq_u32 s55, 1
    s_cbranch_scc0 L_early1
    s_add_u32 s61, s61, 18432
    s_cmp_lg_u32 s3, 0
    s_cbranch_scc1 L_fast
    s_cmp_eq_u32 s40, 1
    s_cbranch_scc1 L_earlyG
    s_cmp_gt_u32 s40, 2
    s_cbranch_scc1 L_dstep0
    s_cmp_eq_u32 s40, 0
    s_cbranch_scc1 L_fast
    s_branch L_se
L_early1:
    s_mul_i32 s72, s3, 18432
    s_add_u32 m0, s61, s72
    s_add_u32 s60, s60, s72
    s_or_b32 s72, s40, s3
    s_cmp_eq_u32 s72, 1
    s_waitcnt vmcnt(5) lgkmcnt(0)
    s_barrier
    s_cbranch_scc1 L_early2
    ds_read_b32 v63, v35 offset:272
    s_nop 0
    buffer_load_dwordx4 v105, s[12:15], s60 offen lds
    buffer_load_dwordx4 v106, s[12:15], s60 offen offset:512 lds
    buffer_load_dwordx4 v107, s[12:15], s60 offen offset:1536 lds
    buffer_load_dwordx4 v108, s[12:15], s60 offen offset:2560 lds
    buffer_load_dwordx4 v109, s[12:15], s60 offen offset:3584 lds
    s_waitcnt lgkmcnt(0)
    v_readfirstlane_b32 s72, v63
    s_mul_i32 s72, s72, 196
    s_cmp_gt_u32 s72, s32
    s_cbranch_scc0 L_early3
    s_branch L_abort
L_early2:
    s_nop 0
    buffer_load_dwordx4 v105, s[12:15], s60 offen lds
    buffer_load_dwordx4 v106, s[12:15], s60 offen offset:512 lds
    buffer_load_dwordx4 v107, s[12:15], s60 offen offset:1536 lds
    buffer_load_dwordx4 v108, s[12:15], s60 offen offset:2560 lds
    buffer_load_dwordx4 v109, s[12:15], s60 offen offset:3584 lds
L_early3:
    s_add_u32 s61, s61, 18432
    s_bitcmp1_b32 s36, s57
    s_barrier
    s_cbranch_scc1 L_heavy
    s_branch L_fast
L_lsi:
    v_bcnt_u32_b32 v54, v136, 0
    v_ffbl_b32 v143, v136
    s_lshr_b32 s73, s74, 5
    v_cmp_lt_u32 vcc, 8, v54
    v_lshl_add_u32 v55, v143, 2, v22
    s_bcnt1_i32_b32 s73, s73
    s_add_u32 s72, s66, s63
    ds_read_b32 v140, v55
    s_cmp_lt_u32 s73, 4
    s_cselect_b32 s72, 999, s72
    v_mov_b32 v137, v136
    s_cmp_lg_u64 vcc, 0
    s_cselect_b32 s72, 999, s72
    v_mov_b32 v138, 0
    s_and_b32 s73, s74, 31
    v_mov_b32 v139, 0
    s_bitset1_b32 s73, 31
    s_cmp_lt_u32 s72, 256
    s_cselect_b32 s75, s73, s75
    s_cselect_b32 s41, 5, 99
L_se:
    s_lshl1_add_u32 s72, s55, 1
    s_and_b32 s72, s75, s72
    s_cbranch_scc0 L_s1
    s_ff1_i32_b32 s68, s75
    s_set_gpr_idx_on s68, gpr_idx(SRC1)
    s_mul_i32 s72, s68, 52
    v_and_b32 v49, 0xffff0000, v80
    v_lshlrev_b32 v48, 16, v80
    s_set_gpr_idx_off
    s_lshr_b32 s72, s72, 8
    s_mul_i32 s73, s72, 5
    s_mov_b32 m0, s61
    v_cvt_f32_u32 v54, s72
    s_sub_u32 s73, s68, s73
    v_cvt_f32_u32 v55, s73
    s_bitset0_b32 s75, s68
    v_add_f32 v54, v124, v54
    v_add_f32 v55, v125, v55
    v_add_f32 v48, v54, v48
    v_add_f32 v49, v55, v49
    v_mov_b32 v60, s66
    v_cvt_pk_bf16_f32 v54, v48, v49
    v_pk_max_i16 v54, v54, 0
    v_pk_min_i16 v54, v54, s54
    v_and_b32 v49, 0xffff0000, v54
    v_lshlrev_b32 v48, 16, v54
    v_cvt_u32_f32 v51, v49
    v_fract_f32 v53, v49
    v_fract_f32 v52, v48
    v_cvt_u32_f32 v50, v48
    v_mad_u32_u24 v32, v51, v15, v17
    v_cmp_lt_f32 vcc, 0, v53
    v_cmp_lt_f32 s[46:47], 0, v52
    v_lshlrev_b32 v54, 3, v51
    v_and_or_b32 v58, v51, 7, s76
    v_add_f32 v57, v52, v53
    v_and_or_b32 v32, v54, 32, v32
    s_or_b64 s[44:45], s[46:47], vcc
    s_and_b64 s[44:45], s[44:45], s[42:43]
    v_perm_b32 v58, v20, v19, v58
    v_mad_u32_u24 v32, v50, v16, v32
    v_sub_f32 v34, 1.0, v57
    s_and_b64 s[52:53], s[46:47], vcc
    v_mbcnt_lo_u32_b32 v60, s44, v60
    s_bcnt1_i32_b64 s63, s[44:45]
    v_cndmask_b32 v54, v16, v58, vcc
    v_mbcnt_hi_u32_b32 v60, s45, v60
    v_cvt_pk_bf16_f32 v34, v34, v57
    s_and_b64 s[52:53], s[52:53], s[42:43]
    v_add_u32 v33, v32, v54
    v_mad_u32_u24 v59, v60, v18, s34
    s_cbranch_scc1 L_sp4
L_sp3:
    v_and_b32 v56, -16, v59
    v_cndmask_b32 v59, v32, v59, s[44:45]
    s_mov_b64 exec, s[44:45]
    ds_write_b128 v56, v[32:35]
    s_mov_b64 exec, -1
L_sp5:
    s_set_gpr_idx_on s68, gpr_idx(DST)
    s_add_u32 s66, s66, s63
    v_mov_b32 v80, v59
    s_set_gpr_idx_off
    s_cmp_lg_u32 s63, 0
    s_cselect_b32 s72, s68, 99
    s_min_u32 s64, s64, s72
    s_cmp_lt_u32 s55, 2
    s_cbranch_scc1 L_se
L_s1:
    v_cmp_ge_u32 vcc, s55, v142
    s_sub_u32 s63, s66, s65
    s_cmp_le_u32 s64, s55
    s_cselect_b32 s72, 0, 12
    s_cmp_lg_u64 vcc, 0
    s_cselect_b32 s72, 0, s72
    s_cmp_eq_u32 s75, 0
    s_cselect_b32 s72, 0, s72
    s_cselect_b32 s73, 2, 0
    s_cselect_b32 s36, s37, s36
    s_cmp_ge_u32 s63, s72
    s_cselect_b32 s63, s63, 0
    s_cselect_b32 s65, s66, s65
    s_cselect_b32 s64, 99, s64
    s_cselect_b32 s72, 99, 0
    s_lshl_b32 s63, s63, 18
    s_or_b32 s63, s63, s73
    v_max_u32 v142, s72, v142
    s_bitcmp1_b32 s74, s56
    s_cbranch_scc1 L_s2
    s_set_gpr_idx_on s58, gpr_idx(SRC0)
    s_nop 0
    v_add_u32 v59, v7, v12
    s_set_gpr_idx_off
    s_branch L_s3
L_s2:
    s_cmp_ge_u32 s56, s41
    s_cbranch_scc1 L_s2l
    s_set_gpr_idx_on s56, gpr_idx(SRC0)
    s_nop 0
    v_mov_b32 v59, v80
    s_set_gpr_idx_off
L_s3:
    s_mov_b32 m0, s61
    s_add_u32 s56, s56, 1
    s_add_u32 s58, s58, 1
    s_sub_u32 s57, s57, 1
    s_mov_b32 s60, s59
    s_add_u32 s59, s59, 18432
    v_or_b32 v59, s63, v59
    s_cmp_lt_u32 s55, 2
    ds_write_b32 v14, v59
    s_cbranch_scc1 L_early
    buffer_load_dwordx4 v108, s[12:15], s60 offen offset:2560 lds
    v_xor_b32 v14, 0x100, v14
    s_xor_b32 s70, s70, s71
    s_sub_u32 s68, s69, s68
    s_cmp_eq_u32 s58, 5
    s_cbranch_scc1 L_wrapS
L_w0S:
    s_add_u32 s62, s62, 1
    s_cmp_eq_u32 s62, 3
    s_cselect_b32 s72, s82, s83
    s_cselect_b32 s62, 0, s62
    buffer_load_dwordx4 v109, s[12:15], s60 offen offset:3584 lds
    s_add_u32 s61, s61, s72
    s_add_u32 s55, s55, 1
    s_bitcmp1_b32 s36, s57
    s_waitcnt vmcnt(6) lgkmcnt(0)
    s_barrier
    s_cbranch_scc1 L_sdstep
    s_branch L_fast
L_wrapS:
    v_add_u32 v13, 1, v13
    s_mov_b32 s58, 0
    v_add_f32 v1, 1.0, v1
    v_med3_i32 v12, v13, 0, s77
    v_add_f32 v127, 0xc0a00000, v127
    v_mul_u32_u24 v12, v12, v16
    s_branch L_w0S
L_s2l:
    s_bfm_b32 s72, s56, 0
    s_set_gpr_idx_on s58, gpr_idx(SRC0)
    s_lshl_b32 s73, 1, s56
    v_add_u32 v59, v7, v12
    s_set_gpr_idx_off
    v_and_b32 v54, s72, v136
    v_and_b32 v56, s73, v136
    v_bcnt_u32_b32 v54, v54, 0
    v_cmp_ne_u32 vcc, 0, v56
    v_lshlrev_b32 v54, 3, v54
    v_lshrrev_b64 v[54:55], v54, v[138:139]
    v_and_b32 v54, 0xff, v54
    v_mad_u32_u24 v54, v54, v18, s34
    v_cndmask_b32 v59, v59, v54, vcc
    s_branch L_s3
L_x0:
.p2align 6
L_fast:
    s_set_gpr_idx_on s58, gpr_idx(SRC0)
    s_add_u32 s56, s56, 1
    v_add_u32 v59, v7, v12
    s_set_gpr_idx_off
    s_add_u32 s58, s58, 1
    s_sub_u32 s57, s57, 1
    s_mov_b32 s60, s59
    s_add_u32 s59, s59, 18432
L_wrF:
    ds_write_b32 v14, v59
L_wr2F:
    s_cmp_lt_u32 s55, 2
    s_cbranch_scc1 L_early
L_wr3F:
    s_mov_b32 m0, s61
    s_nop 0
    buffer_load_dwordx4 v105, s[12:15], s60 offen lds
    buffer_load_dwordx4 v106, s[12:15], s60 offen offset:512 lds
    s_waitcnt vmcnt(1)
    buffer_load_dwordx4 v107, s[12:15], s60 offen offset:1536 lds
    buffer_load_dwordx4 v108, s[12:15], s60 offen offset:2560 lds
    s_waitcnt vmcnt(1)
    buffer_load_dwordx4 v109, s[12:15], s60 offen offset:3584 lds
L_nwF:
    s_setprio 0
    v_xor_b32 v14, 0x100, v14
    s_xor_b32 s70, s70, s71
    s_sub_u32 s68, s69, s68
    s_cmp_eq_u32 s58, 5
    s_cbranch_scc1 L_wrapF
L_w0F:
    s_add_u32 s62, s62, 1
    s_cmp_eq_u32 s62, 3
    s_cselect_b32 s72, s82, s83
    s_cselect_b32 s62, 0, s62
    s_add_u32 s61, s61, s72
    s_add_u32 s55, s55, 1
    s_bitcmp1_b32 s36, s57
    s_waitcnt vmcnt(5) lgkmcnt(0)
    s_barrier
    s_cbranch_scc1 L_heavy
    s_branch L_fast
L_heavy:
    s_cmp_gt_u32 s40, 1
    s_cbranch_scc1 L_sdstep
    s_setprio 3
    s_bitcmp1_b32 s37, s57
    s_cbranch_scc1 L_rare0
L_heavy2:
    s_set_gpr_idx_on s56, gpr_idx(SRC1)
    s_nop 0
    v_and_b32 v49, 0xffff0000, v80
    v_lshlrev_b32 v48, 16, v80
    s_set_gpr_idx_off
    s_mov_b32 m0, s61
    s_add_u32 s56, s56, 1
    s_add_u32 s58, s58, 1
    s_sub_u32 s57, s57, 1
    s_mov_b32 s60, s59
    s_add_u32 s59, s59, 18432
    v_cvt_u32_f32 v51, v49
    buffer_load_dwordx4 v105, s[12:15], s60 offen lds
    v_fract_f32 v53, v49
    v_fract_f32 v52, v48
    v_cvt_u32_f32 v50, v48
    v_mad_u32_u24 v32, v51, v15, v17
    v_cmp_lt_f32 vcc, 0, v53
    v_cmp_lt_f32 s[46:47], 0, v52
    v_lshlrev_b32 v54, 3, v51
    v_and_or_b32 v58, v51, 7, s76
    buffer_load_dwordx4 v106, s[12:15], s60 offen offset:512 lds
    v_add_f32 v57, v52, v53
    v_and_or_b32 v32, v54, 32, v32
    s_or_b64 s[44:45], s[46:47], vcc
    s_or_b64 s[44:45], s[44:45], s[48:49]
    s_and_b64 s[44:45], s[44:45], s[42:43]
    v_perm_b32 v58, v20, v19, v58
    v_mad_u32_u24 v32, v50, v16, v32
    v_sub_f32 v34, 1.0, v57
    s_bcnt1_i32_b64 s63, s[44:45]
    buffer_load_dwordx4 v107, s[12:15], s60 offen offset:1536 lds
L_h3:
    s_and_b64 s[52:53], s[46:47], vcc
    s_or_b64 s[52:53], s[52:53], s[48:49]
    s_and_b64 s[52:53], s[52:53], s[42:43]
    s_cbranch_scc1 L_four
    v_mbcnt_lo_u32_b32 v60, s44, 0
    v_cndmask_b32 v54, v16, v58, vcc
    v_mbcnt_hi_u32_b32 v60, s45, v60
    v_cvt_pk_bf16_f32 v34, v34, v57
    s_cmp_gt_u32 s63, s33
    v_add_u32 v33, v32, v54
    s_cbranch_scc1 L_ovf2
    s_lshl_b32 s72, s63, 18
    v_lshl_add_u32 v56, v60, 4, s70
    v_or_b32 v59, s72, v32
    s_or_b32 s72, s72, s68
    s_mov_b64 exec, s[44:45]
    ds_write_b128 v56, v[32:35]
    v_mad_u32_u24 v59, v60, v18, s72
    s_mov_b64 exec, -1
L_wrH:
    ds_write_b32 v14, v59
L_wr2H:
    s_cmp_lt_u32 s55, 2
    s_cbranch_scc1 L_early
L_wr3H:
    buffer_load_dwordx4 v108, s[12:15], s60 offen offset:2560 lds
    v_xor_b32 v14, 0x100, v14
    s_xor_b32 s70, s70, s71
    s_sub_u32 s68, s69, s68
    s_cmp_eq_u32 s58, 5
    s_cbranch_scc1 L_wrapH
L_w0H:
    s_add_u32 s62, s62, 1
    s_cmp_eq_u32 s62, 3
    s_cselect_b32 s72, s82, s83
    s_cselect_b32 s62, 0, s62
    buffer_load_dwordx4 v109, s[12:15], s60 offen offset:3584 lds
    s_add_u32 s61, s61, s72
    s_add_u32 s55, s55, 1
    s_bitcmp1_b32 s36, s57
    s_waitcnt vmcnt(5) lgkmcnt(0)
    s_barrier
    s_cbranch_scc1 L_heavy
    s_branch L_fast
L_wrapF:
    v_add_u32 v13, 1, v13
    s_mov_b32 s58, 0
    v_add_f32 v1, 1.0, v1
    v_med3_i32 v12, v13, 0, s77
    v_add_f32 v127, 0xc0a00000, v127
    v_mul_u32_u24 v12, v12, v16
    s_branch L_w0F
L_wrapH:
    v_add_u32 v13, 1, v13
    s_mov_b32 s58, 0
    v_add_f32 v1, 1.0, v1
    v_med3_i32 v12, v13, 0, s77
    v_add_f32 v127, 0xc0a00000, v127
    v_mul_u32_u24 v12, v12, v16
    s_branch L_w0H
L_term:
    v_mov_b32 v59, 1
    ds_write_b32 v14, v59
    s_waitcnt vmcnt(0) lgkmcnt(0)
    s_barrier
L_end:
    s_endpgm
L_qstep:
    s_cmp_eq_u32 s57, 0
    s_cbranch_scc1 L_term
    s_cmp_eq_u32 s55, 12
    s_cbranch_scc1 L_qver
L_q0:
    s_cmp_eq_u32 s55, 25
    s_cbranch_scc0 L_q1
    v_add_u32 v13, -5, v13
    s_mov_b32 s59, 0
    v_mul_u32_u24 v12, v13, v16
L_q1:
    s_set_gpr_idx_on s58, gpr_idx(SRC0)
    s_lshr_b32 s72, 33554436, s55
    v_add_u32 v59, v7, v12
    s_set_gpr_idx_off
    s_add_u32 s56, s56, 1
    s_add_u32 s58, s58, 1
    s_sub_u32 s57, s57, 1
    s_mov_b32 s60, s59
    s_add_u32 s59, s59, 18432
    s_mov_b32 m0, s61
    v_and_or_b32 v59, s72, 1, v59
    s_cmp_eq_u32 s55, 2
    ds_write_b32 v14, v59
    s_cbranch_scc1 L_nwF
    buffer_load_dwordx4 v105, s[12:15], s60 offen lds
    buffer_load_dwordx4 v106, s[12:15], s60 offen offset:512 lds
    buffer_load_dwordx4 v107, s[12:15], s60 offen offset:1536 lds
    buffer_load_dwordx4 v108, s[12:15], s60 offen offset:2560 lds
    buffer_load_dwordx4 v109, s[12:15], s60 offen offset:3584 lds
    s_branch L_nwF
L_qver:
    ds_read_b128 v[64:67], v35 offset:256
    s_waitcnt lgkmcnt(0)
    v_or3_b32 v64, v64, v65, v66
    v_or_b32 v64, v64, v67
    v_cmp_ne_u32 vcc, 0, v64
    s_cmp_eq_u64 vcc, 0
    s_cbranch_scc1 L_q0
    v_mov_b32 v59, 3
    ds_write_b32 v14, v59
    s_waitcnt vmcnt(0) lgkmcnt(0)
    s_barrier
    s_barrier
    s_branch L_rst
L_sdstep:
    s_cmp_eq_u32 s57, 0
    s_cbranch_scc1 L_term
    s_cmp_gt_u32 s40, 2
    s_cbranch_scc1 L_dstep
    s_cmp_lt_u32 s55, 4
    s_cselect_b32 s72, 31, -1
    s_mov_b32 s60, s59
    s_and_b32 s72, s72, s75
    s_cbranch_scc1 L_spw
    s_mov_b32 m0, s61
    s_nop 0
    buffer_load_dwordx4 v105, s[12:15], s60 offen lds
    buffer_load_dwordx4 v106, s[12:15], s60 offen offset:512 lds
    s_waitcnt vmcnt(1)
    buffer_load_dwordx4 v107, s[12:15], s60 offen offset:1536 lds
    s_branch L_s1
L_dstep:
    s_setprio 0
    s_set_gpr_idx_on s56, gpr_idx(SRC1)
    s_nop 0
    v_and_b32 v49, 0xffff0000, v80
    v_lshlrev_b32 v48, 16, v80
    s_set_gpr_idx_off
    s_mov_b32 m0, s61
    s_add_u32 s56, s56, 1
    s_add_u32 s58, s58, 1
    s_sub_u32 s57, s57, 1
    s_mov_b32 s60, s59
    s_add_u32 s59, s59, 18432
    v_add_f32 v49, v127, v49
    v_add_f32 v48, v1, v48
    buffer_load_dwordx4 v105, s[12:15], s60 offen lds
    v_add_f32 v127, 1.0, v127
    v_cvt_pk_bf16_f32 v54, v48, v49
    v_pk_max_i16 v54, v54, 0
    v_pk_min_i16 v54, v54, s54
    v_and_b32 v49, 0xffff0000, v54
    v_lshlrev_b32 v48, 16, v54
    v_cvt_u32_f32 v51, v49
    buffer_load_dwordx4 v106, s[12:15], s60 offen offset:512 lds
    v_fract_f32 v53, v49
    v_fract_f32 v52, v48
    v_cvt_u32_f32 v50, v48
    v_mad_u32_u24 v32, v51, v15, v17
    v_cmp_lt_f32 vcc, 0, v53
    v_cmp_lt_f32 s[46:47], 0, v52
    v_lshlrev_b32 v54, 3, v51
    v_and_or_b32 v58, v51, 7, s76
    buffer_load_dwordx4 v107, s[12:15], s60 offen offset:1536 lds
    v_add_f32 v57, v52, v53
    v_and_or_b32 v32, v54, 32, v32
    s_or_b64 s[44:45], s[46:47], vcc
    s_and_b64 s[44:45], s[44:45], s[42:43]
    v_perm_b32 v58, v20, v19, v58
    v_mad_u32_u24 v32, v50, v16, v32
    v_sub_f32 v34, 1.0, v57
    s_branch L_d1
L_ls:
    v_cmp_ne_u32 s[50:51], 0, v137
    s_mov_b32 s8, s90
    v_add_u32 v56, -1, v137
    s_and_b32 s9, s91, 0xffff
    v_mul_u32_u24 v54, 52, v143
    s_mov_b32 s10, 5017600
    v_and_b32 v137, v137, v56
    s_mov_b32 s11, 0x00020000
    v_lshrrev_b32 v54, 8, v54
    v_min_u32 v142, v143, v142
    v_mad_i32_i24 v55, v54, -5, v143
    v_ffbl_b32 v143, v137
    v_cmp_ne_u32 vcc, 0, v137
    s_waitcnt vmcnt(5)
    v_and_b32 v49, 0xffff0000, v140
    v_lshlrev_b32 v48, 16, v140
    v_lshl_add_u32 v56, v143, 2, v141
    s_mov_b32 m0, s61
    s_and_b64 exec, vcc, vcc
    s_cselect_b32 s75, s75, 0
    s_or_b32 exec_lo, exec_lo, 1
    buffer_load_dword v140, v56, s[8:11], 0 offen
L_ls1:
    s_mov_b64 exec, -1
    v_cvt_f32_u32 v54, v54
    v_cvt_f32_u32 v55, v55
    buffer_load_dwordx4 v105, s[12:15], s60 offen lds
    v_add_f32 v54, v124, v54
    v_add_f32 v55, v125, v55
    v_add_f32 v48, v54, v48
    v_add_f32 v49, v55, v49
    v_mov_b32 v60, s66
    v_cvt_pk_bf16_f32 v54, v48, v49
    v_pk_max_i16 v54, v54, 0
    v_pk_min_i16 v54, v54, s54
    v_and_b32 v49, 0xffff0000, v54
    v_lshlrev_b32 v48, 16, v54
    v_cvt_u32_f32 v51, v49
    buffer_load_dwordx4 v106, s[12:15], s60 offen offset:512 lds
    v_fract_f32 v53, v49
    v_fract_f32 v52, v48
    v_cvt_u32_f32 v50, v48
    v_mad_u32_u24 v32, v51, v15, v17
    v_cmp_lt_f32 vcc, 0, v53
    v_cmp_lt_f32 s[46:47], 0, v52
    v_lshlrev_b32 v54, 3, v51
    v_and_or_b32 v58, v51, 7, s76
    v_add_f32 v57, v52, v53
    v_and_or_b32 v32, v54, 32, v32
    s_or_b64 s[44:45], s[46:47], vcc
    s_and_b64 s[44:45], s[44:45], s[42:43]
    v_perm_b32 v58, v20, v19, v58
    v_mad_u32_u24 v32, v50, v16, v32
    v_sub_f32 v34, 1.0, v57
    s_and_b64 s[52:53], s[46:47], vcc
    v_mbcnt_lo_u32_b32 v60, s50, v60
    s_bcnt1_i32_b64 s63, s[50:51]
    v_cndmask_b32 v54, v16, v58, vcc
    v_mbcnt_hi_u32_b32 v60, s51, v60
    v_cndmask_b32 v54, 0, v54, s[44:45]
    v_cvt_pk_bf16_f32 v34, v34, v57
    buffer_load_dwordx4 v107, s[12:15], s60 offen offset:1536 lds
    s_mov_b64 s[44:45], s[50:51]
    s_and_b64 s[52:53], s[52:53], s[50:51]
    v_add_u32 v33, v32, v54
    v_mad_u32_u24 v59, v60, v18, s34
    s_cbranch_scc1 L_sp4l
    v_and_b32 v56, -16, v59
    s_mov_b64 exec, s[44:45]
    ds_write_b128 v56, v[32:35]
    s_mov_b64 exec, -1
L_ls5:
    s_lshr_b32 s72, s67, 5
    s_set_gpr_idx_on s72, gpr_idx(SRC2,DST)
    s_add_u32 s66, s66, s63
    v_lshl_or_b32 v138, v60, s67, v138
    s_set_gpr_idx_off
    s_add_u32 s67, s67, 8
    s_branch L_s1
L_spw:
    s_cmp_eq_u32 s75, 0x80000000
    s_cbranch_scc1 L_ls
    s_ff1_i32_b32 s68, s75
    s_set_gpr_idx_on s68, gpr_idx(SRC1)
    s_mul_i32 s72, s68, 52
    v_and_b32 v49, 0xffff0000, v80
    v_lshlrev_b32 v48, 16, v80
    s_set_gpr_idx_off
    s_lshr_b32 s72, s72, 8
    s_mul_i32 s73, s72, 5
    s_mov_b32 m0, s61
    v_cvt_f32_u32 v54, s72
    s_sub_u32 s73, s68, s73
    buffer_load_dwordx4 v105, s[12:15], s60 offen lds
    v_cvt_f32_u32 v55, s73
    s_bitset0_b32 s75, s68
    v_add_f32 v54, v124, v54
    v_add_f32 v55, v125, v55
    v_add_f32 v48, v54, v48
    v_add_f32 v49, v55, v49
    v_mov_b32 v60, s66
    v_cvt_pk_bf16_f32 v54, v48, v49
    v_pk_max_i16 v54, v54, 0
    v_pk_min_i16 v54, v54, s54
    v_and_b32 v49, 0xffff0000, v54
    v_lshlrev_b32 v48, 16, v54
    v_cvt_u32_f32 v51, v49
    buffer_load_dwordx4 v106, s[12:15], s60 offen offset:512 lds
    v_fract_f32 v53, v49
    v_fract_f32 v52, v48
    v_cvt_u32_f32 v50, v48
    v_mad_u32_u24 v32, v51, v15, v17
    v_cmp_lt_f32 vcc, 0, v53
    v_cmp_lt_f32 s[46:47], 0, v52
    v_lshlrev_b32 v54, 3, v51
    v_and_or_b32 v58, v51, 7, s76
    v_add_f32 v57, v52, v53
    v_and_or_b32 v32, v54, 32, v32
    s_or_b64 s[44:45], s[46:47], vcc
    s_and_b64 s[44:45], s[44:45], s[42:43]
    v_perm_b32 v58, v20, v19, v58
    v_mad_u32_u24 v32, v50, v16, v32
    v_sub_f32 v34, 1.0, v57
    s_and_b64 s[52:53], s[46:47], vcc
    v_mbcnt_lo_u32_b32 v60, s44, v60
    s_bcnt1_i32_b64 s63, s[44:45]
    v_cndmask_b32 v54, v16, v58, vcc
    v_mbcnt_hi_u32_b32 v60, s45, v60
    v_cvt_pk_bf16_f32 v34, v34, v57
    buffer_load_dwordx4 v107, s[12:15], s60 offen offset:1536 lds
    s_and_b64 s[52:53], s[52:53], s[42:43]
    v_add_u32 v33, v32, v54
    v_mad_u32_u24 v59, v60, v18, s34
    s_waitcnt vmcnt(3)
    s_cbranch_scc1 L_sp4
    s_branch L_sp3
L_d4:
    v_cndmask_b32 v58, 0, v58, vcc
    v_cndmask_b32 v57, 0, v16, s[46:47]
    v_sub_f32 v54, 1.0, v52
    v_sub_f32 v55, 1.0, v53
    v_cvt_pk_bf16_f32 v54, v54, v55
    v_mul_f32 v56, v52, v53
    v_and_b32 v55, 0xffff0000, v54
    v_lshlrev_b32 v54, 16, v54
    v_mul_f32 v38, v54, v55
    v_mul_f32 v39, v54, v53
    v_mul_f32 v54, v52, v55
    v_add_u32 v40, v32, v58
    v_add_u32 v33, v32, v57
    v_cvt_pk_bf16_f32 v38, v38, v54
    v_cvt_pk_bf16_f32 v39, v39, v56
    v_add_u32 v41, v40, v57
    s_and_b64 exec, s[42:43], 0xffff
    ds_write2_b32 v126, v38, v39 offset0:0 offset1:4
    ds_write2_b32 v14, v32, v33 offset0:0 offset1:4
    ds_write2_b32 v14, v40, v41 offset0:2 offset1:6
    s_branch L_d3
L_d2p:
    s_setprio 3
    s_bitcmp1_b32 s66, 0
    s_cbranch_scc0 L_peb
    s_mul_i32 s72, s66, 196
    s_add_u32 s72, s72, s34
    s_andn2_b32 s72, s72, 15
    v_mov_b32 v56, s72
    s_add_u32 s66, s66, 1
    ds_write2_b32 v56, v35, v35 offset0:0 offset1:1
L_peb:
    v_sub_f32 v54, 1.0, v52
    v_sub_f32 v55, 1.0, v53
    v_cvt_pk_bf16_f32 v54, v54, v55
    v_mul_f32 v56, v52, v53
    v_and_b32 v55, 0xffff0000, v54
    v_lshlrev_b32 v54, 16, v54
    v_mul_f32 v38, v54, v55
    v_mul_f32 v39, v54, v53
    v_mul_f32 v54, v52, v55
    v_add_u32 v40, v32, v58
    v_add_u32 v41, v32, v16
    v_cvt_pk_bf16_f32 v38, v38, v56
    v_cvt_pk_bf16_f32 v39, v39, v54
    v_mbcnt_lo_u32_b32 v55, s52, 0
    v_mov_b32 v36, v32
    v_mbcnt_hi_u32_b32 v55, s53, v55
    v_add_u32 v37, v40, v16
    v_lshl_add_u32 v55, v55, 1, s66
    s_bcnt1_i32_b64 s72, s[52:53]
    s_mov_b64 exec, s[52:53]
    v_mad_u32_u24 v59, v55, v18, s34
    v_and_b32 v56, -16, v59
    v_add_u32 v54, 196, v59
    ds_write_b128 v56, v[36:39]
    v_and_b32 v54, -16, v54
    ds_write_b64 v54, v[40:41]
    v_mov_b32 v32, v59
    v_mov_b32 v33, v59
    v_mov_b32 v34, 0x3f80
    s_mov_b64 exec, -1
    s_lshl_b32 s72, s72, 1
    s_add_u32 s66, s66, s72
    s_sub_u32 s72, s66, s65
    s_mov_b32 s65, s66
    s_lshl_b32 s72, s72, 18
    s_or_b32 s63, s63, s72
    s_branch L_d2
L_sp4:
    s_bitcmp1_b32 s66, 0
    s_cbranch_scc0 L_pea
    s_mul_i32 s72, s66, 196
    s_add_u32 s72, s72, s34
    s_andn2_b32 s72, s72, 15
    v_mov_b32 v56, s72
    s_add_u32 s66, s66, 1
    ds_write2_b32 v56, v35, v35 offset0:0 offset1:1
L_pea:
    v_sub_f32 v54, 1.0, v52
    v_sub_f32 v55, 1.0, v53
    v_cvt_pk_bf16_f32 v54, v54, v55
    v_mul_f32 v56, v52, v53
    v_and_b32 v55, 0xffff0000, v54
    v_lshlrev_b32 v54, 16, v54
    v_mul_f32 v38, v54, v55
    v_mul_f32 v39, v54, v53
    v_mul_f32 v54, v52, v55
    v_add_u32 v40, v32, v58
    v_add_u32 v41, v32, v16
    v_cvt_pk_bf16_f32 v38, v38, v56
    v_cvt_pk_bf16_f32 v39, v39, v54
    v_mbcnt_lo_u32_b32 v55, s52, 0
    v_mov_b32 v36, v32
    v_mbcnt_hi_u32_b32 v55, s53, v55
    v_add_u32 v37, v40, v16
    v_lshl_add_u32 v55, v55, 1, s66
    s_bcnt1_i32_b64 s72, s[52:53]
    s_andn2_b64 s[50:51], s[44:45], s[52:53]
    s_add_u32 s63, s63, s72
    s_lshl_b32 s72, s72, 1
    s_add_u32 s72, s72, s66
    v_mov_b32 v60, s72
    v_mov_b32 v59, v32
    v_mbcnt_lo_u32_b32 v60, s50, v60
    s_mov_b64 exec, s[52:53]
    v_mad_u32_u24 v59, v55, v18, s34
    v_and_b32 v56, -16, v59
    v_add_u32 v54, 196, v59
    ds_write_b128 v56, v[36:39]
    v_and_b32 v54, -16, v54
    ds_write_b64 v54, v[40:41]
    s_mov_b64 exec, -1
    v_mbcnt_hi_u32_b32 v60, s51, v60
    s_and_b64 exec, s[50:51], s[50:51]
    s_cbranch_scc0 L_sp6
    v_mad_u32_u24 v59, v60, v18, s34
    v_and_b32 v56, -16, v59
    ds_write_b128 v56, v[32:35]
L_sp6:
    s_mov_b64 exec, -1
    s_branch L_sp5
L_sp4l:
    s_bitcmp1_b32 s66, 0
    s_cbranch_scc0 L_peal
    s_mul_i32 s72, s66, 196
    s_add_u32 s72, s72, s34
    s_andn2_b32 s72, s72, 15
    v_mov_b32 v56, s72
    s_add_u32 s66, s66, 1
    ds_write2_b32 v56, v35, v35 offset0:0 offset1:1
L_peal:
    v_sub_f32 v54, 1.0, v52
    v_sub_f32 v55, 1.0, v53
    v_cvt_pk_bf16_f32 v54, v54, v55
    v_mul_f32 v56, v52, v53
    v_and_b32 v55, 0xffff0000, v54
    v_lshlrev_b32 v54, 16, v54
    v_mul_f32 v38, v54, v55
    v_mul_f32 v39, v54, v53
    v_mul_f32 v54, v52, v55
    v_add_u32 v40, v32, v58
    v_add_u32 v41, v32, v16
    v_cvt_pk_bf16_f32 v38, v38, v56
    v_cvt_pk_bf16_f32 v39, v39, v54
    v_mbcnt_lo_u32_b32 v55, s52, 0
    v_mov_b32 v36, v32
    v_mbcnt_hi_u32_b32 v55, s53, v55
    v_add_u32 v37, v40, v16
    v_lshl_add_u32 v55, v55, 1, s66
    s_bcnt1_i32_b64 s72, s[52:53]
    s_andn2_b64 s[50:51], s[44:45], s[52:53]
    s_add_u32 s63, s63, s72
    s_lshl_b32 s72, s72, 1
    s_add_u32 s72, s72, s66
    v_mov_b32 v60, s72
    v_mov_b32 v59, v32
    v_mbcnt_lo_u32_b32 v60, s50, v60
    s_mov_b64 exec, s[52:53]
    v_mad_u32_u24 v59, v55, v18, s34
    v_and_b32 v56, -16, v59
    v_add_u32 v54, 196, v59
    ds_write_b128 v56, v[36:39]
    v_and_b32 v54, -16, v54
    ds_write_b64 v54, v[40:41]
    s_mov_b64 exec, -1
    v_mbcnt_hi_u32_b32 v60, s51, v60
    s_and_b64 exec, s[50:51], s[50:51]
    s_cbranch_scc0 L_sp6l
    v_mad_u32_u24 v59, v60, v18, s34
    v_and_b32 v56, -16, v59
    ds_write_b128 v56, v[32:35]
L_sp6l:
    s_mov_b64 exec, -1
    v_cndmask_b32 v60, v60, v55, s[52:53]
    s_branch L_ls5
L_ovfl:
    s_barrier
L_abort:
    s_waitcnt vmcnt(0)
    s_barrier
    s_branch L_rst2
L_earlyG:
    s_waitcnt lgkmcnt(0)
    s_barrier
    ds_read_b32 v63, v21
    s_waitcnt lgkmcnt(0)
    v_and_b32 v54, 0x10000, v63
    v_cmp_ne_u32 vcc, 0, v54
    s_cmp_lg_u64 vcc, 0
    s_cselect_b32 s67, -1, 0
    s_or_b32 s36, s36, s67
    s_or_b32 s37, s37, s67
    s_branch L_rare0
L_gen:
    v_mov_b32 v32, 0
    v_mov_b32 v33, 0
    v_lshl_add_u32 v70, v0, 4, s70
    s_mov_b32 s40, 1
    ds_write_b128 v70, v[32:35]
    s_waitcnt lgkmcnt(1)
    s_branch L_pre
L_st:
    ds_write_b32 v45, v54
    s_or_b32 s36, s74, 50331649
    s_or_b32 s37, s75, 50331649
    s_branch L_rare1
L_pre:
    s_sub_u32 s33, 159232, s34
    s_lshr_b32 s33, s33, 9
    s_mul_i32 s33, s33, 171
    s_lshr_b32 s33, s33, 9
    s_min_u32 s33, s33, 32
    s_andn2_b32 s33, s33, 1
    s_mul_i32 s29, s33, 192
    s_add_u32 s29, s29, 64
    s_mul_i32 s68, s29, s21
    s_add_u32 s68, s68, s34
    s_lshl_b32 s29, s29, 2
    s_lshl_b32 s69, s68, 1
    s_add_u32 s69, s69, s29
    s_add_u32 s72, s31, s26
    s_sub_u32 s72, s72, 1
    s_min_u32 s72, s72, 223
    v_cvt_f32_u32 v72, s26
    v_cvt_f32_u32 v70, s72
    s_sub_u32 s72, s35, 2
    s_add_u32 s73, s25, s30
    v_cvt_f32_u32 v29, s25
    v_cvt_f32_u32 v30, s72
    v_cvt_f32_u32 v31, s73
    v_cvt_pk_bf16_f32 v29, v29, v72
    v_cvt_pk_bf16_f32 v30, v30, v70
    v_cvt_pk_bf16_f32 v31, v31, v70
    v_add_f32 v2, 0, v127
    v_cvt_f32_u32 v24, v24
    v_add_f32 v3, 1.0, v127
    v_cvt_f32_u32 v25, v25
    v_add_f32 v4, 2.0, v127
    v_cvt_f32_u32 v26, v26
    v_add_f32 v5, 0x40400000, v127
    v_cvt_f32_u32 v27, v27
    v_add_f32 v6, 4.0, v127
    v_cvt_f32_u32 v28, v28
    v_mov_b32 v47, v30
    v_mov_b32 v74, 0
    s_mov_b32 s73, 0
    s_mov_b32 s74, 0
    s_mov_b32 s75, 0
    s_mov_b32 s63, 0x435f0000
    s_mov_b64 exec, s[42:43]
L_pp:
    s_set_gpr_idx_on s73, gpr_idx(SRC1)
    s_lshl_b32 s75, s75, 5
    v_lshlrev_b32 v64, 16, v80
    v_and_b32 v69, 0xffff0000, v80
    v_lshlrev_b32 v65, 16, v81
    v_and_b32 v70, 0xffff0000, v81
    v_lshlrev_b32 v66, 16, v82
    v_and_b32 v71, 0xffff0000, v82
    v_lshlrev_b32 v67, 16, v83
    v_and_b32 v72, 0xffff0000, v83
    v_lshlrev_b32 v68, 16, v84
    v_and_b32 v73, 0xffff0000, v84
    s_set_gpr_idx_off
    v_med3_f32 v23, v1, 0, s63
    v_add_f32 v64, v1, v64
    v_add_f32 v69, v2, v69
    v_add_f32 v65, v1, v65
    v_add_f32 v70, v3, v70
    v_add_f32 v66, v1, v66
    v_add_f32 v71, v4, v71
    v_add_f32 v67, v1, v67
    v_add_f32 v72, v5, v72
    v_add_f32 v68, v1, v68
    v_add_f32 v73, v6, v73
    v_lshrrev_b32 v23, 16, v23
    v_add_f32 v1, 1.0, v1
    v_cvt_pk_bf16_f32 v64, v64, v69
    v_cvt_pk_bf16_f32 v65, v65, v70
    v_cvt_pk_bf16_f32 v66, v66, v71
    v_cvt_pk_bf16_f32 v67, v67, v72
    v_cvt_pk_bf16_f32 v68, v68, v73
    v_pk_max_i16 v64, v64, 0
    v_pk_max_i16 v65, v65, 0
    v_pk_max_i16 v66, v66, 0
    v_pk_max_i16 v67, v67, 0
    v_pk_max_i16 v68, v68, 0
    v_pk_min_i16 v64, v64, s54
    v_pk_min_i16 v65, v65, s54
    v_pk_min_i16 v66, v66, s54
    v_pk_min_i16 v67, v67, s54
    v_pk_min_i16 v68, v68, s54
    v_bitop3_b32 v69, v64, v23, v24 bitop3:0x96
    v_bitop3_b32 v70, v65, v23, v25 bitop3:0x96
    v_bitop3_b32 v71, v66, v23, v26 bitop3:0x96
    v_bitop3_b32 v72, v67, v23, v27 bitop3:0x96
    v_bitop3_b32 v73, v68, v23, v28 bitop3:0x96
    v_cmp_ne_u32 s[44:45], 0, v69
    v_cmp_ne_u32 s[46:47], 0, v70
    v_cmp_ne_u32 s[50:51], 0, v71
    v_cmp_ne_u32 s[52:53], 0, v72
    v_cmp_ne_u32 s[78:79], 0, v73
    v_pk_maximum3_f16 v61, v64, v65, v47
    v_pk_minimum3_f16 v62, v64, v65, v29
    s_set_gpr_idx_on s73, gpr_idx(DST)
    s_add_u32 s73, s73, 5
    v_mov_b32 v80, v64
    v_mov_b32 v81, v65
    v_mov_b32 v82, v66
    v_mov_b32 v83, v67
    v_mov_b32 v84, v68
    s_set_gpr_idx_off
    v_pk_maximum3_f16 v61, v66, v67, v61
    v_pk_minimum3_f16 v62, v66, v67, v62
    s_cmp_lg_u64 s[44:45], 0
    s_addc_u32 s74, s74, s74
    v_pk_max_i16 v61, v68, v61
    v_pk_min_i16 v62, v68, v62
    s_cmp_lg_u64 s[46:47], 0
    s_addc_u32 s74, s74, s74
    v_or3_b32 v74, v69, v70, v74
    s_cmp_lg_u64 s[50:51], 0
    s_addc_u32 s74, s74, s74
    v_cmp_ne_u32 vcc, v61, v47
    v_cmp_ne_u32 s[44:45], v62, v29
    s_cmp_lg_u64 s[52:53], 0
    s_addc_u32 s74, s74, s74
    v_or3_b32 v74, v71, v72, v74
    s_cmp_lg_u64 s[78:79], 0
    s_addc_u32 s74, s74, s74
    v_or_b32 v74, v73, v74
    v_mov_b32 v47, v31
    s_or_b64 vcc, vcc, s[44:45]
    s_cselect_b32 s72, 31, 0
    s_or_b32 s75, s75, s72
    s_cmp_lt_u32 s73, 25
    s_cbranch_scc1 L_pp
    v_cmp_ne_u16 s[50:51], 0, v74
    v_cmp_lt_u32 vcc, 0xffff, v74
    s_lshl_b32 s74, s74, 1
    s_lshl_b32 s75, s75, 1
    s_mov_b64 exec, -1
    s_bcnt1_i32_b64 s72, s[50:51]
    s_bcnt1_i32_b64 s73, vcc
    s_add_u32 s72, s72, s73
    s_cmp_gt_u32 s72, s33
    s_cselect_b32 s72, 3, 2
    s_cmp_eq_u32 s74, 0
    s_cselect_b32 s72, 0, s72
    s_lshl_b32 s72, s72, 16
    v_mov_b32 v54, s72
    s_branch L_st
L_rare0:
    s_cmp_lg_u32 s3, 0
    s_cbranch_scc1 L_qstep
    s_cmp_lg_u32 s67, 0
    s_cbranch_scc1 L_ovchk
L_adv:
    s_cmp_eq_u32 s57, 0
    s_cbranch_scc1 L_term
L_rare1:
    s_bitcmp1_b32 s74, s57
    s_cbranch_scc0 L_fast
    s_bitcmp1_b32 s75, s57
    s_cbranch_scc0 L_rare2
    s_cmp_lt_u32 s56, 5
    s_cselect_b64 vcc, -1, 0
    s_set_gpr_idx_on s56, gpr_idx(SRC0)
    s_nop 0
    v_mov_b32 v54, v80
    s_set_gpr_idx_off
    v_cndmask_b32 v55, v31, v30, vcc
    v_pk_max_i16 v56, v54, v29
    v_pk_min_i16 v56, v56, v55
    v_cmp_ne_u32 vcc, v56, v54
    s_and_b64 s[48:49], vcc, s[42:43]
L_rare2:
    s_cmp_lt_u32 s55, 2
    s_cbranch_scc0 L_heavy2
    s_set_gpr_idx_on s56, gpr_idx(SRC1)
    s_nop 0
    v_and_b32 v49, 0xffff0000, v80
    v_lshlrev_b32 v48, 16, v80
    s_set_gpr_idx_off
    s_mov_b32 m0, s61
    s_add_u32 s56, s56, 1
    s_add_u32 s58, s58, 1
    s_sub_u32 s57, s57, 1
    s_mov_b32 s60, s59
    s_add_u32 s59, s59, 18432
    v_cvt_u32_f32 v51, v49
    v_fract_f32 v53, v49
    v_fract_f32 v52, v48
    v_cvt_u32_f32 v50, v48
    v_mad_u32_u24 v32, v51, v15, v17
    v_cmp_lt_f32 vcc, 0, v53
    v_cmp_lt_f32 s[46:47], 0, v52
    v_lshlrev_b32 v54, 3, v51
    v_and_or_b32 v58, v51, 7, s76
    v_add_f32 v57, v52, v53
    v_and_or_b32 v32, v54, 32, v32
    s_or_b64 s[44:45], s[46:47], vcc
    s_or_b64 s[44:45], s[44:45], s[48:49]
    s_and_b64 s[44:45], s[44:45], s[42:43]
    v_perm_b32 v58, v20, v19, v58
    v_mad_u32_u24 v32, v50, v16, v32
    v_sub_f32 v34, 1.0, v57
    s_bcnt1_i32_b64 s63, s[44:45]
    s_branch L_h3
L_four:
    v_cvt_pk_bf16_f32 v34, v34, v57
    v_sub_f32 v54, 1.0, v52
    v_sub_f32 v55, 1.0, v53
    v_cvt_pk_bf16_f32 v54, v54, v55
    v_mul_f32 v56, v52, v53
    v_and_b32 v55, 0xffff0000, v54
    v_lshlrev_b32 v54, 16, v54
    v_mul_f32 v38, v54, v55
    v_mul_f32 v39, v54, v53
    v_mul_f32 v54, v52, v55
    v_mov_b32 v59, v32
    v_cvt_pk_bf16_f32 v38, v38, v56
    v_cvt_pk_bf16_f32 v39, v39, v54
    s_cmp_lg_u64 s[48:49], 0
    s_cbranch_scc1 L_glob
    v_add_u32 v40, v32, v58
    v_add_u32 v41, v32, v16
    s_bcnt1_i32_b64 s72, s[52:53]
    s_andn2_b64 s[50:51], s[44:45], s[52:53]
    s_add_u32 s63, s63, s72
    s_lshl_b32 s72, s72, 1
    v_mbcnt_lo_u32_b32 v55, s52, 0
    v_mov_b32 v60, s72
    v_add_u32 v54, v40, v16
    v_mbcnt_hi_u32_b32 v55, s53, v55
    v_mbcnt_lo_u32_b32 v60, s50, v60
    v_cndmask_b32 v37, v41, v40, vcc
    v_lshlrev_b32 v55, 1, v55
    v_mbcnt_hi_u32_b32 v60, s51, v60
    v_mov_b32 v36, v32
    v_cndmask_b32 v37, v37, v54, s[52:53]
    v_cndmask_b32 v38, v34, v38, s[52:53]
    v_cndmask_b32 v39, v35, v39, s[52:53]
    v_cndmask_b32 v60, v60, v55, s[52:53]
    s_mov_b32 s64, 0
L_emit0:
    s_cmp_gt_u32 s63, s33
    s_cbranch_scc1 L_flag
L_emit:
    v_cmp_gt_u32 vcc, s33, v60
    s_min_u32 s72, s63, s33
    s_lshl_b32 s72, s72, 18
    s_or_b32 s72, s72, s64
    s_sub_i32 s66, s63, s33
    v_cndmask_b32 v59, v59, v35, s[44:45]
    v_lshl_add_u32 v56, v60, 4, s70
    v_or_b32 v59, s72, v59
    s_or_b32 s72, s72, s68
    s_and_b64 exec, s[44:45], vcc
    ds_write_b128 v56, v[36:39]
    v_mad_u32_u24 v59, v60, v18, s72
    s_and_b64 exec, s[52:53], vcc
    ds_write_b64 v56, v[40:41] offset:16
    s_mov_b64 exec, -1
    s_branch L_wrH
L_glob:
    v_addc_co_u32 v54, s[50:51], 0, v51, vcc
    v_addc_co_u32 v55, s[50:51], 0, v50, s[46:47]
    v_mul_u32_u24 v36, 192, v51
    v_mul_u32_u24 v37, 192, v54
    v_mul_u32_u24 v54, 43008, v50
    v_mul_u32_u24 v55, 43008, v55
    v_mbcnt_lo_u32_b32 v60, s44, 0
    v_add_u32 v36, v36, v54
    v_add_u32 v37, v37, v55
    v_mbcnt_hi_u32_b32 v60, s45, v60
    s_mov_b64 s[52:53], 0
    s_mov_b64 s[48:49], 0
    s_mov_b32 s64, 33554432
    s_branch L_emit0
L_ovf2:
    v_mov_b32 v36, v32
    v_mov_b32 v37, v33
    v_mov_b32 v38, v34
    v_mov_b32 v39, 0
    v_mov_b32 v59, v32
    s_mov_b32 s64, 0
    s_branch L_emit0
L_flag:
    s_add_u32 s72, s55, 1
    s_lshl_b32 s72, s72, 8
    s_mov_b32 s73, s33
L_flag1:
    s_add_u32 s72, s72, 1
    s_add_u32 s73, s73, s33
    s_cmp_gt_u32 s63, s73
    s_cbranch_scc1 L_flag1
    v_mov_b32 v54, s72
    ds_write_b16 v45, v54
    s_branch L_emit
L_ovchk:
    s_cmp_lg_u32 s65, 0
    s_cbranch_scc1 L_rep1
    ds_read_b32 v63, v21
    s_waitcnt lgkmcnt(0)
    v_cmp_eq_u32_sdwa vcc, v63, s55 src0_sel:BYTE_1 src1_sel:DWORD
    s_cmp_eq_u64 vcc, 0
    s_cbranch_scc1 L_adv
    v_and_b32 v63, 0xff, v63
    v_cndmask_b32 v63, v35, v63, vcc
    s_nop 0
    v_readlane_b32 s65, v63, 0
    v_readlane_b32 s72, v63, 1
    v_readlane_b32 s73, v63, 2
    v_readlane_b32 s63, v63, 3
    s_max_u32 s65, s65, s72
    s_max_u32 s73, s73, s63
    s_max_u32 s65, s65, s73
L_rep1:
    s_sub_u32 s65, s65, 1
    v_mov_b32 v59, 0
    s_cmp_gt_i32 s66, 0
    s_cbranch_scc0 L_wrF
    s_mov_b32 s63, s66
    v_subrev_u32 v60, s33, v60
    s_cmp_lt_u32 s55, 2
    s_cbranch_scc1 L_emit
    s_mov_b32 m0, s61
    s_nop 0
    buffer_load_dwordx4 v105, s[12:15], s60 offen lds
    buffer_load_dwordx4 v106, s[12:15], s60 offen offset:512 lds
    buffer_load_dwordx4 v107, s[12:15], s60 offen offset:1536 lds
    s_branch L_emit
L_rst2:
    s_bitset1_b32 s2, 31
L_rst:
    s_waitcnt lgkmcnt(0)
    v_mbcnt_lo_u32_b32 v0, -1, 0
    s_mov_b32 s3, 0
    s_lshl_b32 s38, s22, 8
    v_mbcnt_hi_u32_b32 v0, -1, v0
    s_sub_u32 s29, s24, 4
    s_or_b32 s38, s38, s23
    s_lshr_b32 s29, s29, 1
    s_lshl3_add_u32 s38, s27, s38
    s_or_b32 s38, s38, s29
    s_lshr_b32 s29, s20, 2
    s_branch L_sp
L_main:
    s_barrier
    s_add_u32 s29, s30, 1
    s_mul_i32 s34, s29, s28
    s_lshl_b32 s29, s27, 13
    s_add_u32 s34, s34, 57856
    s_sub_u32 s32, 163056, s29
    s_sub_u32 s32, s32, s34
    s_waitcnt lgkmcnt(0)
    s_mov_b32 s16, s94
    s_and_b32 s17, s95, 0xffff
    s_mov_b32 s18, 9633792
    s_mov_b32 s19, 0x00020000
    v_lshlrev_b32 v25, 2, v0
    v_mov_b32 v26, 0
    ds_write_b32 v25, v26
    s_mov_b32 s43, 4294930432
    s_mov_b32 s44, 18432
    s_mov_b32 s40, 0
    s_mov_b32 s49, 0x3fff0
    s_mov_b32 s96, 0
    s_mul_i32 s81, s23, 192
    s_cmp_gt_u32 s24, 12
    s_cselect_b32 s56, s21, 0
    s_and_b32 s56, s56, 1
    s_mov_b32 s80, s21
    s_add_u32 s46, s80, s22
    s_mul_i32 s46, s46, 43008
    s_add_u32 s46, s46, s81
    s_cmp_lt_u32 s80, s24
    s_cselect_b32 s46, s46, 0x40000000
    s_sub_u32 s80, 7, s21
    s_add_u32 s47, s80, s22
    s_mul_i32 s47, s47, 43008
    s_add_u32 s47, s47, s81
    s_cmp_lt_u32 s80, s24
    s_cselect_b32 s47, s47, 0x40000000
    s_sub_u32 s80, 11, s21
    s_add_u32 s48, s80, s22
    s_mul_i32 s48, s48, 43008
    s_add_u32 s48, s48, s81
    s_cmp_lt_u32 s80, s24
    s_cselect_b32 s48, s48, 0x40000000
    s_lshr_b32 s80, s21, 1
    s_add_u32 s80, s80, 12
    s_add_u32 s45, s80, s22
    s_mul_i32 s45, s45, 43008
    s_add_u32 s45, s45, s81
    s_cmp_lt_u32 s80, s24
    s_cselect_b32 s45, s45, 0x40000000
    v_mov_b32 v84, 0
    v_mov_b32 v85, 0
    v_mov_b32 v86, 0
    v_mov_b32 v87, 0
    v_mov_b32 v88, 0
    v_mov_b32 v89, 0
    v_mov_b32 v90, 0
    v_mov_b32 v91, 0
    v_mov_b32 v92, 0
    v_mov_b32 v93, 0
    v_mov_b32 v94, 0
    v_mov_b32 v95, 0
    v_mov_b32 v96, 0
    v_mov_b32 v97, 0
    v_mov_b32 v98, 0
    v_mov_b32 v99, 0
    v_mov_b32 v100, 0
    v_mov_b32 v101, 0
    v_mov_b32 v102, 0
    v_mov_b32 v103, 0
    v_mov_b32 v104, 0
    v_mov_b32 v105, 0
    v_mov_b32 v106, 0
    v_mov_b32 v107, 0
    v_mov_b32 v108, 0
    v_mov_b32 v109, 0
    v_mov_b32 v110, 0
    v_mov_b32 v111, 0
    v_mov_b32 v112, 0
    v_mov_b32 v113, 0
    v_mov_b32 v114, 0
    v_mov_b32 v115, 0
    v_mov_b32 v116, 0
    v_mov_b32 v117, 0
    v_mov_b32 v118, 0
    v_mov_b32 v119, 0
    v_mov_b32 v120, 0
    v_mov_b32 v121, 0
    v_mov_b32 v122, 0
    v_mov_b32 v123, 0
    v_mov_b32 v124, 0
    v_mov_b32 v125, 0
    v_mov_b32 v126, 0
    v_mov_b32 v127, 0
    v_mov_b32 v128, 0
    v_mov_b32 v129, 0
    v_mov_b32 v130, 0
    v_mov_b32 v131, 0
    v_mov_b32 v132, 0
    v_mov_b32 v133, 0
    v_mov_b32 v134, 0
    v_mov_b32 v135, 0
    v_mov_b32 v136, 0
    v_mov_b32 v137, 0
    v_mov_b32 v138, 0
    v_mov_b32 v139, 0
    v_mov_b32 v140, 0
    v_mov_b32 v141, 0
    v_mov_b32 v142, 0
    v_mov_b32 v143, 0
    v_mov_b32 v144, 0
    v_mov_b32 v145, 0
    v_mov_b32 v146, 0
    v_mov_b32 v147, 0
    v_mov_b32 v148, 0
    v_mov_b32 v149, 0
    v_mov_b32 v150, 0
    v_mov_b32 v151, 0
    v_mov_b32 v152, 0
    v_mov_b32 v153, 0
    v_mov_b32 v154, 0
    v_mov_b32 v155, 0
    v_mov_b32 v156, 0
    v_mov_b32 v157, 0
    v_mov_b32 v158, 0
    v_mov_b32 v159, 0
    v_mov_b32 v160, 0
    v_mov_b32 v161, 0
    v_mov_b32 v162, 0
    v_mov_b32 v163, 0
    v_mov_b32 v164, 0
    v_mov_b32 v165, 0
    v_mov_b32 v166, 0
    v_mov_b32 v167, 0
    v_lshrrev_b32 v19, 4, v0
    v_bfe_u32 v22, v0, 2, 2
    v_and_b32 v23, 3, v0
    v_mul_u32_u24 v25, 192, v22
    v_lshl_add_u32 v25, v23, 3, v25
    v_add_u32 v25, 2560, v25
    s_lshl_b32 s80, s56, 7
    s_lshl_b32 s81, s56, 5
    s_waitcnt lgkmcnt(0)
    s_mov_b32 s57, 0
    v_mov_b32 v37, 0
    s_cmp_lg_u32 s3, 0
    s_cselect_b32 s32, -1, s32
    s_cbranch_scc1 L_mf
    v_lshl_add_u32 v2, s21, 6, v0
    v_mul_u32_u24 v3, 171, v2
    v_lshrrev_b32 v3, 11, v3
    v_mul_u32_u24 v4, 12, v3
    v_sub_u32 v4, v2, v4
    v_add_u32 v3, s26, v3
    s_add_u32 s50, s25, 8
    s_lshl_b32 s51, s21, 10
    v_lshrrev_b32 v5, 1, v3
    s_mul_i32 s50, s50, 43008
    s_add_u32 s51, s51, 57856
    v_and_b32 v5, 2, v5
    s_mul_i32 s54, s28, 8
    s_mul_i32 s55, s31, 12
    v_xor_b32 v4, v4, v5
    s_add_u32 m0, s54, s51
    v_mul_u32_u24 v3, 192, v3
    v_cmp_gt_u32 s[52:53], s55, v2
    v_lshl_add_u32 v20, v4, 4, v3
    s_sub_u32 s55, s35, 2
    s_mul_i32 s55, s55, 43008
    s_mov_b32 s6, 9633792
    s_mov_b32 s7, 0x00020000
    s_mov_b32 s4, s88
    s_and_b32 s5, s89, 0xffff
    s_cmp_le_u32 s50, s55
    s_cbranch_scc0 L_xdm
    s_mov_b64 exec, s[52:53]
L_xlm:
    buffer_load_dwordx4 v20, s[4:7], s50 offen nt lds
    s_add_u32 m0, m0, s28
    s_add_u32 s50, s50, 43008
    s_cmp_le_u32 s50, s55
    s_cbranch_scc1 L_xlm
    s_mov_b64 exec, -1
L_xdm:
    s_mul_i32 s59, s21, 4608
    s_lshl_b32 s82, s21, 5
    v_lshl_add_u32 v30, v0, 4, s59
    s_and_b32 s82, s82, 32
    s_add_u32 s59, s59, 2560
    v_xor_b32 v30, s82, v30
    s_mov_b32 s12, s92
    s_and_b32 s13, s93, 0xffff
    v_xor_b32 v31, 32, v30
    s_mov_b32 s14, 460800
    s_mov_b32 s15, 0x00020000
    s_mov_b32 vcc_lo, 0
    s_mov_b32 vcc_hi, 4294901760
    v_cndmask_b32 v32, v30, v31, vcc
    s_mov_b32 vcc_lo, 4294901760
    s_mov_b32 vcc_hi, 4294967295
    v_cndmask_b32 v33, v30, v31, vcc
    s_mov_b32 vcc_lo, 4294967295
    s_mov_b32 vcc_hi, 65535
    v_cndmask_b32 v34, v30, v31, vcc
    s_mov_b32 vcc_lo, 0
    s_mov_b32 vcc_hi, 0
    v_cndmask_b32 v35, v30, v31, vcc
    s_mov_b32 vcc_lo, 4294901760
    s_mov_b32 vcc_hi, 4294967295
    v_cndmask_b32 v36, v30, v31, vcc
    s_mov_b32 m0, s59
    s_bitcmp1_b32 s2, 31
    buffer_load_dwordx4 v32, s[12:15], 0 offen lds
    buffer_load_dwordx4 v33, s[12:15], 0 offen offset:512 lds
    buffer_load_dwordx4 v34, s[12:15], 0 offen offset:1536 lds
    buffer_load_dwordx4 v35, s[12:15], 0 offen offset:2560 lds
    buffer_load_dwordx4 v36, s[12:15], 0 offen offset:3584 lds
    s_cselect_b32 s57, 0, s27
    s_cbranch_scc0 L_m1
    s_barrier
L_m1:
    s_cmp_lg_u32 s57, 0
    s_cbranch_scc1 L_md
L_mf:
    v_mov_b32 v27, 1536
    v_lshlrev_b32 v26, 5, v19
    v_and_b32 v21, 15, v0
    v_and_b32 v26, 32, v26
    s_lshl_b32 s29, s21, 9
    s_add_u32 s29, s29, 512
    v_lshlrev_b32 v7, 4, v19
    v_lshl_add_u32 v0, v21, 4, s29
    v_mad_u32_u24 v24, v19, v27, v25
    v_or_b32 v24, v24, v26
    v_add_u32 v1, s80, v24
    v_xor_b32 v3, s81, v24
    v_subrev_u32 v5, s80, v24
    v_xor_b32 v2, 32, v1
    v_add_u32 v3, 64, v3
    v_add_u32 v5, 0x80, v5
    v_xor_b32 v4, 32, v3
    v_xor_b32 v6, 32, v5
    s_waitcnt vmcnt(0)
    s_barrier
    ds_read_b32 v36, v37 offset:272
    ds_read_b128 v[8:11], v0 offset:0
    v_xor_b32 v0, 0x100, v0
    s_waitcnt lgkmcnt(0)
    v_bitop3_b32 v9, v9, s49, v7 bitop3:0x6a
    v_bitop3_b32 v10, v10, s49, v7 bitop3:0x6a
    v_bitop3_b32 v11, v11, s49, v7 bitop3:0x6a
    v_readfirstlane_b32 s42, v8
    v_bitop3_b32 v8, v8, s49, v7 bitop3:0x6a
    ds_read_b64_tr_b16 v[12:13], v1 offset:0
    ds_read_b64_tr_b16 v[14:15], v2 offset:768
    ds_read_b64_tr_b16 v[16:17], v2 offset:0
    ds_read_b64_tr_b16 v[18:19], v1 offset:768
    ds_read_b64_tr_b16 v[20:21], v3 offset:0
    ds_read_b64_tr_b16 v[22:23], v4 offset:768
    ds_read_b64_tr_b16 v[24:25], v4 offset:0
    ds_read_b64_tr_b16 v[26:27], v3 offset:768
    ds_read_b64_tr_b16 v[28:29], v5 offset:0
    ds_read_b64_tr_b16 v[30:31], v6 offset:768
    ds_read_b64_tr_b16 v[32:33], v6 offset:0
    ds_read_b64_tr_b16 v[34:35], v5 offset:768
    v_readfirstlane_b32 s54, v36
    s_mul_i32 s55, s54, 196
    s_cmp_gt_u32 s55, s32
    s_barrier
    s_cbranch_scc1 L_rst2
    s_cmp_gt_u32 s24, 12
    s_cbranch_scc0 L_n14
    s_cmp_eq_u32 s3, 0
    s_cbranch_scc1 L_p14
    ds_read_b128 v[36:39], v8 offset:0
    ds_read_b128 v[48:51], v9 offset:0
    s_waitcnt lgkmcnt(0)
L_G1:
    s_waitcnt lgkmcnt(10)
    v_mfma_f32_16x16x32_bf16 v[84:87], v[12:15], v[36:39], v[84:87]
    ds_read_b128 v[40:43], v8 offset:64
    v_mfma_f32_16x16x32_bf16 v[108:111], v[12:15], v[48:51], v[108:111]
    s_waitcnt lgkmcnt(9)
    ds_read_b64_tr_b16 v[12:13], v1 offset:6144
    ds_read_b64_tr_b16 v[14:15], v2 offset:6912
    v_mfma_f32_16x16x32_bf16 v[88:91], v[16:19], v[36:39], v[88:91]
    s_nop 0
    ds_read_b128 v[52:55], v9 offset:64
    ds_read_b64_tr_b16 v[60:61], v1 offset:12288
    v_mfma_f32_16x16x32_bf16 v[112:115], v[16:19], v[48:51], v[112:115]
    s_waitcnt lgkmcnt(11)
    ds_read_b64_tr_b16 v[62:63], v2 offset:13056
    ds_read_b64_tr_b16 v[16:17], v2 offset:6144
    v_mfma_f32_16x16x32_bf16 v[92:95], v[20:23], v[36:39], v[92:95]
    s_add_u32 s40, s40, 1
    ds_read_b128 v[44:47], v8 offset:128
    ds_read_b64_tr_b16 v[18:19], v1 offset:6912
    v_mfma_f32_16x16x32_bf16 v[116:119], v[20:23], v[48:51], v[116:119]
    s_waitcnt lgkmcnt(13)
    ds_read_b64_tr_b16 v[64:65], v2 offset:12288
    ds_read_b64_tr_b16 v[66:67], v1 offset:13056
    v_mfma_f32_16x16x32_bf16 v[96:99], v[24:27], v[36:39], v[96:99]
    s_cmp_eq_u32 s40, 3
    ds_read_b128 v[56:59], v9 offset:128
    ds_read_b128 v[8:11], v0 offset:0
    v_mfma_f32_16x16x32_bf16 v[120:123], v[24:27], v[48:51], v[120:123]
    s_waitcnt lgkmcnt(15)
    v_xor_b32 v0, 0x100, v0
    s_cselect_b32 s41, s43, s44
    v_mfma_f32_16x16x32_bf16 v[100:103], v[28:31], v[36:39], v[100:103]
    s_cselect_b32 s40, 0, s40
    ds_read_b64_tr_b16 v[20:21], v3 offset:6144
    ds_read_b64_tr_b16 v[22:23], v4 offset:6912
    v_mfma_f32_16x16x32_bf16 v[124:127], v[28:31], v[48:51], v[124:127]
    s_waitcnt lgkmcnt(15)
    ds_read_b64_tr_b16 v[68:69], v3 offset:12288
    ds_read_b64_tr_b16 v[70:71], v4 offset:13056
    v_mfma_f32_16x16x32_bf16 v[104:107], v[32:35], v[36:39], v[104:107]
    s_nop 0
    ds_read_b64_tr_b16 v[24:25], v4 offset:6144
    ds_read_b64_tr_b16 v[26:27], v3 offset:6912
    v_mfma_f32_16x16x32_bf16 v[128:131], v[32:35], v[48:51], v[128:131]
    s_waitcnt lgkmcnt(15)
    ds_read_b64_tr_b16 v[72:73], v4 offset:12288
    ds_read_b64_tr_b16 v[74:75], v3 offset:13056
    v_mfma_f32_16x16x32_bf16 v[84:87], v[12:15], v[40:43], v[84:87]
    s_nop 0
    ds_read_b64_tr_b16 v[28:29], v5 offset:6144
    ds_read_b64_tr_b16 v[30:31], v6 offset:6912
    v_mfma_f32_16x16x32_bf16 v[108:111], v[12:15], v[52:55], v[108:111]
    s_waitcnt lgkmcnt(14)
    ds_read_b64_tr_b16 v[76:77], v5 offset:12288
    ds_read_b64_tr_b16 v[78:79], v6 offset:13056
    v_mfma_f32_16x16x32_bf16 v[88:91], v[16:19], v[40:43], v[88:91]
    s_waitcnt lgkmcnt(12)
    v_bitop3_b32 v9, v9, s49, v7 bitop3:0x6a
    v_mfma_f32_16x16x32_bf16 v[112:115], v[16:19], v[52:55], v[112:115]
    s_waitcnt lgkmcnt(10)
    v_bitop3_b32 v10, v10, s49, v7 bitop3:0x6a
    v_mfma_f32_16x16x32_bf16 v[92:95], v[20:23], v[40:43], v[92:95]
    v_bitop3_b32 v11, v11, s49, v7 bitop3:0x6a
    v_mfma_f32_16x16x32_bf16 v[116:119], v[20:23], v[52:55], v[116:119]
    s_waitcnt lgkmcnt(6)
    v_readfirstlane_b32 s42, v8
    v_mfma_f32_16x16x32_bf16 v[96:99], v[24:27], v[40:43], v[96:99]
    v_bitop3_b32 v8, v8, s49, v7 bitop3:0x6a
    v_mfma_f32_16x16x32_bf16 v[120:123], v[24:27], v[52:55], v[120:123]
    s_waitcnt lgkmcnt(2)
    ds_read_b64_tr_b16 v[32:33], v6 offset:6144
    ds_read_b64_tr_b16 v[34:35], v5 offset:6912
    v_mfma_f32_16x16x32_bf16 v[100:103], v[28:31], v[40:43], v[100:103]
    s_nop 0
    ds_read_b64_tr_b16 v[80:81], v6 offset:12288
    ds_read_b64_tr_b16 v[82:83], v5 offset:13056
    v_mfma_f32_16x16x32_bf16 v[124:127], v[28:31], v[52:55], v[124:127]
    s_waitcnt lgkmcnt(2)
    v_add_u32 v1, s41, v1
    v_add_u32 v2, s41, v2
    v_mfma_f32_16x16x32_bf16 v[104:107], v[32:35], v[40:43], v[104:107]
    v_add_u32 v3, s41, v3
    v_add_u32 v4, s41, v4
    v_mfma_f32_16x16x32_bf16 v[128:131], v[32:35], v[52:55], v[128:131]
    v_add_u32 v5, s41, v5
    v_add_u32 v6, s41, v6
    v_mfma_f32_16x16x32_bf16 v[84:87], v[60:63], v[44:47], v[84:87]
    v_mfma_f32_16x16x32_bf16 v[108:111], v[60:63], v[56:59], v[108:111]
    v_mfma_f32_16x16x32_bf16 v[88:91], v[64:67], v[44:47], v[88:91]
    v_mfma_f32_16x16x32_bf16 v[112:115], v[64:67], v[56:59], v[112:115]
    v_mfma_f32_16x16x32_bf16 v[92:95], v[68:71], v[44:47], v[92:95]
    s_waitcnt lgkmcnt(0)
    s_barrier
    ds_read_b128 v[36:39], v8 offset:0
    v_mfma_f32_16x16x32_bf16 v[116:119], v[68:71], v[56:59], v[116:119]
    s_nop 0
    ds_read_b128 v[48:51], v9 offset:0
    ds_read_b64_tr_b16 v[12:13], v1 offset:0
    v_mfma_f32_16x16x32_bf16 v[96:99], v[72:75], v[44:47], v[96:99]
    s_nop 0
    ds_read_b64_tr_b16 v[14:15], v2 offset:768
    ds_read_b64_tr_b16 v[16:17], v2 offset:0
    v_mfma_f32_16x16x32_bf16 v[120:123], v[72:75], v[56:59], v[120:123]
    s_nop 0
    ds_read_b64_tr_b16 v[18:19], v1 offset:768
    ds_read_b64_tr_b16 v[20:21], v3 offset:0
    v_mfma_f32_16x16x32_bf16 v[100:103], v[76:79], v[44:47], v[100:103]
    s_nop 0
    ds_read_b64_tr_b16 v[22:23], v4 offset:768
    ds_read_b64_tr_b16 v[24:25], v4 offset:0
    v_mfma_f32_16x16x32_bf16 v[124:127], v[76:79], v[56:59], v[124:127]
    s_nop 0
    ds_read_b64_tr_b16 v[26:27], v3 offset:768
    ds_read_b64_tr_b16 v[28:29], v5 offset:0
    v_mfma_f32_16x16x32_bf16 v[104:107], v[80:83], v[44:47], v[104:107]
    s_bitcmp1_b32 s42, 0
    ds_read_b64_tr_b16 v[30:31], v6 offset:768
    ds_read_b64_tr_b16 v[32:33], v6 offset:0
    v_mfma_f32_16x16x32_bf16 v[128:131], v[80:83], v[56:59], v[128:131]
    ds_read_b64_tr_b16 v[34:35], v5 offset:768
    s_cbranch_scc0 L_G1
    ds_read_b128 v[60:63], v10 offset:0
    ds_read_b128 v[72:75], v11 offset:0
    s_waitcnt lgkmcnt(0)
    s_branch L_F14
L_p14:
    ds_read_b128 v[36:39], v8 offset:0
    ds_read_b128 v[48:51], v9 offset:0
    ds_read_b128 v[60:63], v10 offset:0
    ds_read_b128 v[72:75], v11 offset:0
    s_waitcnt lgkmcnt(0)
.p2align 6
L_F14:
    s_waitcnt lgkmcnt(6)
    v_mfma_f32_16x16x32_bf16 v[84:87], v[12:15], v[36:39], v[84:87]
    ds_read_b64_tr_b16 v[28:29], v5 offset:0
    s_add_u32 s40, s40, 1
    v_mfma_f32_16x16x32_bf16 v[108:111], v[12:15], v[48:51], v[108:111]
    ds_read_b64_tr_b16 v[30:31], v6 offset:768
    s_cmp_eq_u32 s40, 3
    v_mfma_f32_16x16x32_bf16 v[132:135], v[12:15], v[60:63], v[132:135]
    ds_read_b64_tr_b16 v[32:33], v6 offset:0
    s_cselect_b32 s41, s43, s44
    v_mfma_f32_16x16x32_bf16 v[156:159], v[12:15], v[72:75], v[156:159]
    s_waitcnt lgkmcnt(7)
    ds_read_b64_tr_b16 v[34:35], v5 offset:768
    s_cselect_b32 s40, 0, s40
    v_mfma_f32_16x16x32_bf16 v[88:91], v[16:19], v[36:39], v[88:91]
    ds_read_b128 v[40:43], v8 offset:64
    v_mfma_f32_16x16x32_bf16 v[112:115], v[16:19], v[48:51], v[112:115]
    ds_read_b128 v[52:55], v9 offset:64
    v_mfma_f32_16x16x32_bf16 v[136:139], v[16:19], v[60:63], v[136:139]
    ds_read_b128 v[64:67], v10 offset:64
    v_mfma_f32_16x16x32_bf16 v[160:163], v[16:19], v[72:75], v[160:163]
    s_waitcnt lgkmcnt(9)
    ds_read_b128 v[76:79], v11 offset:64
    v_mfma_f32_16x16x32_bf16 v[92:95], v[20:23], v[36:39], v[92:95]
    ds_read_b128 v[44:47], v8 offset:128
    v_mfma_f32_16x16x32_bf16 v[116:119], v[20:23], v[48:51], v[116:119]
    ds_read_b64_tr_b16 v[12:13], v1 offset:6144
    v_mfma_f32_16x16x32_bf16 v[140:143], v[20:23], v[60:63], v[140:143]
    ds_read_b128 v[56:59], v9 offset:128
    v_mfma_f32_16x16x32_bf16 v[164:167], v[20:23], v[72:75], v[164:167]
    s_waitcnt lgkmcnt(11)
    ds_read_b64_tr_b16 v[14:15], v2 offset:6912
    v_mfma_f32_16x16x32_bf16 v[96:99], v[24:27], v[36:39], v[96:99]
    ds_read_b128 v[68:71], v10 offset:128
    v_mfma_f32_16x16x32_bf16 v[120:123], v[24:27], v[48:51], v[120:123]
    ds_read_b64_tr_b16 v[16:17], v2 offset:6144
    v_mfma_f32_16x16x32_bf16 v[144:147], v[24:27], v[60:63], v[144:147]
    s_waitcnt lgkmcnt(12)
    ds_read_b128 v[80:83], v11 offset:128
    v_mfma_f32_16x16x32_bf16 v[100:103], v[28:31], v[36:39], v[100:103]
    ds_read_b128 v[8:11], v0 offset:0
    v_xor_b32 v0, 0x100, v0
    v_mfma_f32_16x16x32_bf16 v[124:127], v[28:31], v[48:51], v[124:127]
    ds_read_b64_tr_b16 v[18:19], v1 offset:6912
    v_mfma_f32_16x16x32_bf16 v[148:151], v[28:31], v[60:63], v[148:151]
    s_waitcnt lgkmcnt(13)
    ds_read_b64_tr_b16 v[20:21], v3 offset:6144
    v_mfma_f32_16x16x32_bf16 v[104:107], v[32:35], v[36:39], v[104:107]
    ds_read_b64_tr_b16 v[22:23], v4 offset:6912
    v_mfma_f32_16x16x32_bf16 v[128:131], v[32:35], v[48:51], v[128:131]
    ds_read_b64_tr_b16 v[24:25], v4 offset:6144
    v_mfma_f32_16x16x32_bf16 v[152:155], v[32:35], v[60:63], v[152:155]
    s_waitcnt lgkmcnt(8)
    ds_read_b64_tr_b16 v[26:27], v3 offset:6912
    v_mfma_f32_16x16x32_bf16 v[84:87], v[12:15], v[40:43], v[84:87]
    ds_read_b64_tr_b16 v[28:29], v5 offset:6144
    v_mfma_f32_16x16x32_bf16 v[108:111], v[12:15], v[52:55], v[108:111]
    ds_read_b64_tr_b16 v[30:31], v6 offset:6912
    v_mfma_f32_16x16x32_bf16 v[132:135], v[12:15], v[64:67], v[132:135]
    s_waitcnt lgkmcnt(7)
    v_bitop3_b32 v9, v9, s49, v7 bitop3:0x6a
    v_mfma_f32_16x16x32_bf16 v[156:159], v[12:15], v[76:79], v[156:159]
    s_waitcnt lgkmcnt(6)
    v_bitop3_b32 v10, v10, s49, v7 bitop3:0x6a
    v_mfma_f32_16x16x32_bf16 v[88:91], v[16:19], v[40:43], v[88:91]
    v_bitop3_b32 v11, v11, s49, v7 bitop3:0x6a
    v_mfma_f32_16x16x32_bf16 v[112:115], v[16:19], v[52:55], v[112:115]
    v_readfirstlane_b32 s42, v8
    v_mfma_f32_16x16x32_bf16 v[136:139], v[16:19], v[64:67], v[136:139]
    v_bitop3_b32 v8, v8, s49, v7 bitop3:0x6a
    v_mfma_f32_16x16x32_bf16 v[160:163], v[16:19], v[76:79], v[160:163]
    s_waitcnt lgkmcnt(4)
    ds_read_b64_tr_b16 v[32:33], v6 offset:6144
    v_mfma_f32_16x16x32_bf16 v[92:95], v[20:23], v[40:43], v[92:95]
    ds_read_b64_tr_b16 v[34:35], v5 offset:6912
    v_mfma_f32_16x16x32_bf16 v[116:119], v[20:23], v[52:55], v[116:119]
    ds_read_b64_tr_b16 v[12:13], v1 offset:12288
    v_mfma_f32_16x16x32_bf16 v[140:143], v[20:23], v[64:67], v[140:143]
    ds_read_b64_tr_b16 v[14:15], v2 offset:13056
    v_mfma_f32_16x16x32_bf16 v[164:167], v[20:23], v[76:79], v[164:167]
    s_waitcnt lgkmcnt(6)
    ds_read_b64_tr_b16 v[16:17], v2 offset:12288
    v_mfma_f32_16x16x32_bf16 v[96:99], v[24:27], v[40:43], v[96:99]
    ds_read_b64_tr_b16 v[18:19], v1 offset:13056
    v_mfma_f32_16x16x32_bf16 v[120:123], v[24:27], v[52:55], v[120:123]
    ds_read_b64_tr_b16 v[20:21], v3 offset:12288
    v_mfma_f32_16x16x32_bf16 v[144:147], v[24:27], v[64:67], v[144:147]
    s_waitcnt lgkmcnt(7)
    ds_read_b64_tr_b16 v[22:23], v4 offset:13056
    v_mfma_f32_16x16x32_bf16 v[100:103], v[28:31], v[40:43], v[100:103]
    ds_read_b64_tr_b16 v[24:25], v4 offset:12288
    v_mfma_f32_16x16x32_bf16 v[124:127], v[28:31], v[52:55], v[124:127]
    ds_read_b64_tr_b16 v[26:27], v3 offset:13056
    v_mfma_f32_16x16x32_bf16 v[148:151], v[28:31], v[64:67], v[148:151]
    s_waitcnt lgkmcnt(8)
    ds_read_b64_tr_b16 v[28:29], v5 offset:12288
    v_mfma_f32_16x16x32_bf16 v[104:107], v[32:35], v[40:43], v[104:107]
    ds_read_b64_tr_b16 v[30:31], v6 offset:13056
    v_mfma_f32_16x16x32_bf16 v[128:131], v[32:35], v[52:55], v[128:131]
    v_mfma_f32_16x16x32_bf16 v[152:155], v[32:35], v[64:67], v[152:155]
    s_waitcnt lgkmcnt(8)
    ds_read_b64_tr_b16 v[32:33], v6 offset:12288
    v_mfma_f32_16x16x32_bf16 v[84:87], v[12:15], v[44:47], v[84:87]
    ds_read_b64_tr_b16 v[34:35], v5 offset:13056
    v_add_u32 v1, s41, v1
    v_mfma_f32_16x16x32_bf16 v[108:111], v[12:15], v[56:59], v[108:111]
    v_add_u32 v2, s41, v2
    v_add_u32 v3, s41, v3
    v_mfma_f32_16x16x32_bf16 v[132:135], v[12:15], v[68:71], v[132:135]
    v_add_u32 v4, s41, v4
    v_add_u32 v5, s41, v5
    v_mfma_f32_16x16x32_bf16 v[156:159], v[12:15], v[80:83], v[156:159]
    s_waitcnt lgkmcnt(8)
    v_add_u32 v6, s41, v6
    v_mfma_f32_16x16x32_bf16 v[88:91], v[16:19], v[44:47], v[88:91]
    v_mfma_f32_16x16x32_bf16 v[112:115], v[16:19], v[56:59], v[112:115]
    v_mfma_f32_16x16x32_bf16 v[136:139], v[16:19], v[68:71], v[136:139]
    v_mfma_f32_16x16x32_bf16 v[160:163], v[16:19], v[80:83], v[160:163]
    s_waitcnt lgkmcnt(6)
    v_mfma_f32_16x16x32_bf16 v[92:95], v[20:23], v[44:47], v[92:95]
    s_waitcnt lgkmcnt(0)
    s_barrier
    ds_read_b128 v[36:39], v8 offset:0
    v_mfma_f32_16x16x32_bf16 v[116:119], v[20:23], v[56:59], v[116:119]
    ds_read_b128 v[48:51], v9 offset:0
    v_mfma_f32_16x16x32_bf16 v[140:143], v[20:23], v[68:71], v[140:143]
    ds_read_b128 v[60:63], v10 offset:0
    v_mfma_f32_16x16x32_bf16 v[164:167], v[20:23], v[80:83], v[164:167]
    ds_read_b128 v[72:75], v11 offset:0
    v_mfma_f32_16x16x32_bf16 v[96:99], v[24:27], v[44:47], v[96:99]
    ds_read_b64_tr_b16 v[12:13], v1 offset:0
    v_mfma_f32_16x16x32_bf16 v[120:123], v[24:27], v[56:59], v[120:123]
    ds_read_b64_tr_b16 v[14:15], v2 offset:768
    v_mfma_f32_16x16x32_bf16 v[144:147], v[24:27], v[68:71], v[144:147]
    ds_read_b64_tr_b16 v[16:17], v2 offset:0
    v_mfma_f32_16x16x32_bf16 v[100:103], v[28:31], v[44:47], v[100:103]
    ds_read_b64_tr_b16 v[18:19], v1 offset:768
    v_mfma_f32_16x16x32_bf16 v[124:127], v[28:31], v[56:59], v[124:127]
    ds_read_b64_tr_b16 v[20:21], v3 offset:0
    v_mfma_f32_16x16x32_bf16 v[148:151], v[28:31], v[68:71], v[148:151]
    ds_read_b64_tr_b16 v[22:23], v4 offset:768
    v_mfma_f32_16x16x32_bf16 v[104:107], v[32:35], v[44:47], v[104:107]
    ds_read_b64_tr_b16 v[24:25], v4 offset:0
    v_mfma_f32_16x16x32_bf16 v[128:131], v[32:35], v[56:59], v[128:131]
    s_bitcmp1_b32 s42, 0
    ds_read_b64_tr_b16 v[26:27], v3 offset:768
    v_mfma_f32_16x16x32_bf16 v[152:155], v[32:35], v[68:71], v[152:155]
    s_cbranch_scc0 L_F14
    s_waitcnt lgkmcnt(0)
    v_mbcnt_lo_u32_b32 v36, -1, 0
    s_lshl_b32 s50, s56, 7
    v_mbcnt_hi_u32_b32 v36, -1, v36
    s_lshl_b32 s51, s56, 5
    v_and_b32 v37, 15, v36
    v_lshrrev_b32 v38, 1, v36
    v_mul_u32_u24 v37, 192, v37
    v_lshlrev_b32 v39, 1, v36
    v_and_b32 v38, 24, v38
    v_and_b32 v39, 32, v39
    s_lshl_b32 s52, s21, 9
    v_and_b32 v38, 16, v38
    s_add_u32 s52, s52, 512
    v_lshl_add_u32 v43, v36, 3, s52
    v_add3_u32 v37, v37, v38, v39
    v_add_u32 v40, s50, v37
    v_xor_b32 v41, s51, v37
    v_subrev_u32 v42, s50, v37
    v_add_u32 v41, 64, v41
    v_add_u32 v42, 0x80, v42
    s_cmp_lg_u32 s3, 0
    s_cbranch_scc1 L_q2
L_eT:
    v_cvt_pk_bf16_f32 v164, v164, v165
    v_cvt_pk_bf16_f32 v165, v166, v167
    v_cvt_pk_bf16_f32 v156, v156, v157
    v_cvt_pk_bf16_f32 v157, v158, v159
    ds_write_b64 v43, v[164:165]
    v_cvt_pk_bf16_f32 v158, v160, v161
    v_cvt_pk_bf16_f32 v159, v162, v163
    s_nop 0
    v_permlane16_swap_b32 v156, v158
    v_permlane16_swap_b32 v157, v159
    buffer_store_dwordx4 v[156:159], v40, s[16:19], s45 offen sc0 sc1
L_e2:
    v_cvt_pk_bf16_f32 v132, v132, v133
    v_cvt_pk_bf16_f32 v133, v134, v135
    v_cvt_pk_bf16_f32 v134, v136, v137
    v_cvt_pk_bf16_f32 v135, v138, v139
    v_cvt_pk_bf16_f32 v140, v140, v141
    v_cvt_pk_bf16_f32 v141, v142, v143
    v_cvt_pk_bf16_f32 v142, v144, v145
    v_cvt_pk_bf16_f32 v143, v146, v147
    v_cvt_pk_bf16_f32 v148, v148, v149
    v_cvt_pk_bf16_f32 v149, v150, v151
    v_cvt_pk_bf16_f32 v150, v152, v153
    v_cvt_pk_bf16_f32 v151, v154, v155
    v_permlane16_swap_b32 v132, v134
    v_permlane16_swap_b32 v133, v135
    buffer_store_dwordx4 v[132:135], v40, s[16:19], s48 offen sc0 sc1
    v_permlane16_swap_b32 v140, v142
    v_permlane16_swap_b32 v141, v143
    buffer_store_dwordx4 v[140:143], v41, s[16:19], s48 offen sc0 sc1
    v_permlane16_swap_b32 v148, v150
    v_permlane16_swap_b32 v149, v151
    buffer_store_dwordx4 v[148:151], v42, s[16:19], s48 offen sc0 sc1
    s_cmp_lg_u32 s3, 0
    s_cbranch_scc1 L_e3
L_e1:
    v_cvt_pk_bf16_f32 v108, v108, v109
    v_cvt_pk_bf16_f32 v109, v110, v111
    v_cvt_pk_bf16_f32 v110, v112, v113
    v_cvt_pk_bf16_f32 v111, v114, v115
    v_cvt_pk_bf16_f32 v116, v116, v117
    v_cvt_pk_bf16_f32 v117, v118, v119
    v_cvt_pk_bf16_f32 v118, v120, v121
    v_cvt_pk_bf16_f32 v119, v122, v123
    v_cvt_pk_bf16_f32 v124, v124, v125
    v_cvt_pk_bf16_f32 v125, v126, v127
    v_cvt_pk_bf16_f32 v126, v128, v129
    v_cvt_pk_bf16_f32 v127, v130, v131
    v_permlane16_swap_b32 v108, v110
    v_permlane16_swap_b32 v109, v111
    buffer_store_dwordx4 v[108:111], v40, s[16:19], s47 offen sc0 sc1
    v_permlane16_swap_b32 v116, v118
    v_permlane16_swap_b32 v117, v119
    buffer_store_dwordx4 v[116:119], v41, s[16:19], s47 offen sc0 sc1
    v_permlane16_swap_b32 v124, v126
    v_permlane16_swap_b32 v125, v127
    buffer_store_dwordx4 v[124:127], v42, s[16:19], s47 offen sc0 sc1
L_e0:
    v_cvt_pk_bf16_f32 v84, v84, v85
    v_cvt_pk_bf16_f32 v85, v86, v87
    v_cvt_pk_bf16_f32 v86, v88, v89
    v_cvt_pk_bf16_f32 v87, v90, v91
    v_cvt_pk_bf16_f32 v92, v92, v93
    v_cvt_pk_bf16_f32 v93, v94, v95
    v_cvt_pk_bf16_f32 v94, v96, v97
    v_cvt_pk_bf16_f32 v95, v98, v99
    v_cvt_pk_bf16_f32 v100, v100, v101
    v_cvt_pk_bf16_f32 v101, v102, v103
    v_cvt_pk_bf16_f32 v102, v104, v105
    v_cvt_pk_bf16_f32 v103, v106, v107
    v_permlane16_swap_b32 v84, v86
    v_permlane16_swap_b32 v85, v87
    buffer_store_dwordx4 v[84:87], v40, s[16:19], s46 offen sc0 sc1
    v_permlane16_swap_b32 v92, v94
    v_permlane16_swap_b32 v93, v95
    buffer_store_dwordx4 v[92:95], v41, s[16:19], s46 offen sc0 sc1
    v_permlane16_swap_b32 v100, v102
    v_permlane16_swap_b32 v101, v103
    buffer_store_dwordx4 v[100:103], v42, s[16:19], s46 offen sc0 sc1
L_e3:
    s_cmp_gt_u32 s24, 12
    s_cbranch_scc0 L_ex
    s_cmp_eq_u32 s56, 0
    s_waitcnt lgkmcnt(0)
    s_barrier
    s_cbranch_scc0 L_ex
    ds_read_b64 v[166:167], v43 offset:512
    s_waitcnt lgkmcnt(0)
    v_permlane16_swap_b32 v164, v166
    v_permlane16_swap_b32 v165, v167
    buffer_store_dwordx4 v[164:167], v41, s[16:19], s45 offen sc0 sc1
L_ex:
    s_endpgm
L_q2:
    s_bitcmp1_b32 s42, 1
    s_cbranch_scc1 L_rst
    v_cvt_pk_bf16_f32 v84, v84, v85
    v_cvt_pk_bf16_f32 v85, v86, v87
    v_cvt_pk_bf16_f32 v86, v88, v89
    v_cvt_pk_bf16_f32 v87, v90, v91
    v_mov_b32 v88, v40
    v_mov_b32 v89, v41
    v_mov_b32 v90, v42
    v_mov_b32 v91, v43
    v_mfma_f32_16x16x32_bf16 v[132:135], v[12:15], v[60:63], v[132:135]
    s_nop 0
    ds_read_b64_tr_b16 v[28:29], v5 offset:0
    ds_read_b64_tr_b16 v[30:31], v6 offset:768
    ds_read_b64_tr_b16 v[32:33], v6 offset:0
    v_mfma_f32_16x16x32_bf16 v[156:159], v[12:15], v[72:75], v[156:159]
    s_nop 0
    ds_read_b64_tr_b16 v[34:35], v5 offset:768
    ds_read_b128 v[64:67], v10 offset:64
    v_mfma_f32_16x16x32_bf16 v[136:139], v[16:19], v[60:63], v[136:139]
    s_nop 0
    ds_read_b128 v[76:79], v11 offset:64
    ds_read_b64_tr_b16 v[12:13], v1 offset:6144
    ds_read_b64_tr_b16 v[14:15], v2 offset:6912
    v_mfma_f32_16x16x32_bf16 v[160:163], v[16:19], v[72:75], v[160:163]
    s_nop 0
    ds_read_b64_tr_b16 v[36:37], v1 offset:12288
    ds_read_b64_tr_b16 v[38:39], v2 offset:13056
    ds_read_b64_tr_b16 v[16:17], v2 offset:6144
    v_mfma_f32_16x16x32_bf16 v[140:143], v[20:23], v[60:63], v[140:143]
    s_add_u32 s40, s40, 1
    ds_read_b128 v[68:71], v10 offset:128
    ds_read_b64_tr_b16 v[18:19], v1 offset:6912
    ds_read_b64_tr_b16 v[40:41], v2 offset:12288
    v_mfma_f32_16x16x32_bf16 v[164:167], v[20:23], v[72:75], v[164:167]
    s_nop 0
    ds_read_b64_tr_b16 v[42:43], v1 offset:13056
    ds_read_b64_tr_b16 v[20:21], v3 offset:6144
    ds_read_b64_tr_b16 v[22:23], v4 offset:6912
    v_mfma_f32_16x16x32_bf16 v[144:147], v[24:27], v[60:63], v[144:147]
    s_waitcnt lgkmcnt(15)
    ds_read_b128 v[80:83], v11 offset:128
    ds_read_b128 v[8:11], v0 offset:0
    v_xor_b32 v0, 0x100, v0
    v_mfma_f32_16x16x32_bf16 v[148:151], v[28:31], v[60:63], v[148:151]
    s_waitcnt lgkmcnt(15)
    ds_read_b64_tr_b16 v[44:45], v3 offset:12288
    ds_read_b64_tr_b16 v[46:47], v4 offset:13056
    ds_read_b64_tr_b16 v[24:25], v4 offset:6144
    v_mfma_f32_16x16x32_bf16 v[152:155], v[32:35], v[60:63], v[152:155]
    s_waitcnt lgkmcnt(14)
    ds_read_b64_tr_b16 v[26:27], v3 offset:6912
    ds_read_b64_tr_b16 v[28:29], v5 offset:6144
    ds_read_b64_tr_b16 v[30:31], v6 offset:6912
    v_mfma_f32_16x16x32_bf16 v[132:135], v[12:15], v[64:67], v[132:135]
    s_nop 0
    ds_read_b64_tr_b16 v[48:49], v4 offset:12288
    ds_read_b64_tr_b16 v[50:51], v3 offset:13056
    ds_read_b64_tr_b16 v[32:33], v6 offset:6144
    v_mfma_f32_16x16x32_bf16 v[156:159], v[12:15], v[76:79], v[156:159]
    s_waitcnt lgkmcnt(15)
    ds_read_b64_tr_b16 v[34:35], v5 offset:6912
    ds_read_b64_tr_b16 v[52:53], v5 offset:12288
    ds_read_b64_tr_b16 v[54:55], v6 offset:13056
    v_mfma_f32_16x16x32_bf16 v[136:139], v[16:19], v[64:67], v[136:139]
    s_cmp_eq_u32 s40, 3
    ds_read_b64_tr_b16 v[56:57], v6 offset:12288
    ds_read_b64_tr_b16 v[58:59], v5 offset:13056
    s_cselect_b32 s41, s43, s44
    v_mfma_f32_16x16x32_bf16 v[160:163], v[16:19], v[76:79], v[160:163]
    s_waitcnt lgkmcnt(15)
    s_cselect_b32 s40, 0, s40
    v_add_u32 v1, s41, v1
    v_add_u32 v2, s41, v2
    v_mfma_f32_16x16x32_bf16 v[140:143], v[20:23], v[64:67], v[140:143]
    v_add_u32 v3, s41, v3
    v_add_u32 v4, s41, v4
    v_add_u32 v5, s41, v5
    v_mfma_f32_16x16x32_bf16 v[164:167], v[20:23], v[76:79], v[164:167]
    s_waitcnt lgkmcnt(10)
    v_bitop3_b32 v9, v9, s49, v7 bitop3:0x6a
    v_add_u32 v6, s41, v6
    v_mfma_f32_16x16x32_bf16 v[144:147], v[24:27], v[64:67], v[144:147]
    s_waitcnt lgkmcnt(8)
    v_bitop3_b32 v10, v10, s49, v7 bitop3:0x6a
    v_permlane16_swap_b32 v84, v86
    v_mfma_f32_16x16x32_bf16 v[148:151], v[28:31], v[64:67], v[148:151]
    s_waitcnt lgkmcnt(4)
    v_bitop3_b32 v11, v11, s49, v7 bitop3:0x6a
    v_permlane16_swap_b32 v85, v87
    v_mfma_f32_16x16x32_bf16 v[152:155], v[32:35], v[64:67], v[152:155]
    v_readfirstlane_b32 s42, v8
    v_mfma_f32_16x16x32_bf16 v[132:135], v[36:39], v[68:71], v[132:135]
    v_bitop3_b32 v8, v8, s49, v7 bitop3:0x6a
    buffer_store_dwordx4 v[84:87], v88, s[16:19], s46 offen sc0 sc1
    v_cvt_pk_bf16_f32 v92, v92, v93
    v_mfma_f32_16x16x32_bf16 v[156:159], v[36:39], v[80:83], v[156:159]
    s_waitcnt lgkmcnt(0)
    s_barrier
    ds_read_b128 v[60:63], v10 offset:0
    v_mfma_f32_16x16x32_bf16 v[136:139], v[40:43], v[68:71], v[136:139]
    s_nop 0
    ds_read_b128 v[72:75], v11 offset:0
    ds_read_b64_tr_b16 v[12:13], v1 offset:0
    ds_read_b64_tr_b16 v[14:15], v2 offset:768
    v_mfma_f32_16x16x32_bf16 v[160:163], v[40:43], v[80:83], v[160:163]
    s_nop 0
    ds_read_b64_tr_b16 v[16:17], v2 offset:0
    ds_read_b64_tr_b16 v[18:19], v1 offset:768
    ds_read_b64_tr_b16 v[20:21], v3 offset:0
    v_mfma_f32_16x16x32_bf16 v[140:143], v[44:47], v[68:71], v[140:143]
    s_nop 0
    ds_read_b64_tr_b16 v[22:23], v4 offset:768
    ds_read_b64_tr_b16 v[24:25], v4 offset:0
    ds_read_b64_tr_b16 v[26:27], v3 offset:768
    v_mfma_f32_16x16x32_bf16 v[164:167], v[44:47], v[80:83], v[164:167]
    s_nop 0
    ds_read_b64_tr_b16 v[28:29], v5 offset:0
    ds_read_b64_tr_b16 v[30:31], v6 offset:768
    ds_read_b64_tr_b16 v[32:33], v6 offset:0
    v_mfma_f32_16x16x32_bf16 v[144:147], v[48:51], v[68:71], v[144:147]
    ds_read_b64_tr_b16 v[34:35], v5 offset:768
    v_cvt_pk_bf16_f32 v93, v94, v95
    v_cvt_pk_bf16_f32 v94, v96, v97
    v_mfma_f32_16x16x32_bf16 v[148:151], v[52:55], v[68:71], v[148:151]
    v_cvt_pk_bf16_f32 v95, v98, v99
    v_permlane16_swap_b32 v92, v94
    v_mfma_f32_16x16x32_bf16 v[152:155], v[56:59], v[68:71], v[152:155]
    v_permlane16_swap_b32 v93, v95
    buffer_store_dwordx4 v[92:95], v89, s[16:19], s46 offen sc0 sc1
    v_cvt_pk_bf16_f32 v100, v100, v101
    v_cvt_pk_bf16_f32 v101, v102, v103
    v_cvt_pk_bf16_f32 v102, v104, v105
    v_cvt_pk_bf16_f32 v103, v106, v107
    s_nop 0
    v_permlane16_swap_b32 v100, v102
    v_permlane16_swap_b32 v101, v103
    buffer_store_dwordx4 v[100:103], v90, s[16:19], s46 offen sc0 sc1
    s_waitcnt lgkmcnt(10)
    v_mfma_f32_16x16x32_bf16 v[132:135], v[12:15], v[60:63], v[132:135]
    ds_read_b128 v[64:67], v10 offset:64
    v_cvt_pk_bf16_f32 v108, v108, v109
    v_mfma_f32_16x16x32_bf16 v[156:159], v[12:15], v[72:75], v[156:159]
    s_waitcnt lgkmcnt(9)
    ds_read_b64_tr_b16 v[12:13], v1 offset:6144
    ds_read_b64_tr_b16 v[14:15], v2 offset:6912
    ds_read_b64_tr_b16 v[36:37], v1 offset:12288
    v_mfma_f32_16x16x32_bf16 v[136:139], v[16:19], v[60:63], v[136:139]
    s_nop 0
    ds_read_b128 v[76:79], v11 offset:64
    ds_read_b64_tr_b16 v[38:39], v2 offset:13056
    v_cvt_pk_bf16_f32 v109, v110, v111
    v_mfma_f32_16x16x32_bf16 v[160:163], v[16:19], v[72:75], v[160:163]
    s_waitcnt lgkmcnt(12)
    ds_read_b64_tr_b16 v[16:17], v2 offset:6144
    ds_read_b64_tr_b16 v[18:19], v1 offset:6912
    ds_read_b64_tr_b16 v[40:41], v2 offset:12288
    v_mfma_f32_16x16x32_bf16 v[140:143], v[20:23], v[60:63], v[140:143]
    s_nop 0
    ds_read_b128 v[68:71], v10 offset:128
    ds_read_b64_tr_b16 v[42:43], v1 offset:13056
    v_cvt_pk_bf16_f32 v110, v112, v113
    v_mfma_f32_16x16x32_bf16 v[164:167], v[20:23], v[72:75], v[164:167]
    s_waitcnt lgkmcnt(15)
    ds_read_b64_tr_b16 v[20:21], v3 offset:6144
    ds_read_b64_tr_b16 v[22:23], v4 offset:6912
    ds_read_b64_tr_b16 v[44:45], v3 offset:12288
    v_mfma_f32_16x16x32_bf16 v[144:147], v[24:27], v[60:63], v[144:147]
    s_waitcnt lgkmcnt(15)
    ds_read_b128 v[80:83], v11 offset:128
    ds_read_b64_tr_b16 v[46:47], v4 offset:13056
    ds_read_b64_tr_b16 v[24:25], v4 offset:6144
    v_mfma_f32_16x16x32_bf16 v[148:151], v[28:31], v[60:63], v[148:151]
    s_waitcnt lgkmcnt(15)
    ds_read_b64_tr_b16 v[26:27], v3 offset:6912
    ds_read_b64_tr_b16 v[28:29], v5 offset:6144
    ds_read_b64_tr_b16 v[30:31], v6 offset:6912
    v_mfma_f32_16x16x32_bf16 v[152:155], v[32:35], v[60:63], v[152:155]
    s_waitcnt lgkmcnt(15)
    ds_read_b64_tr_b16 v[48:49], v4 offset:12288
    ds_read_b64_tr_b16 v[50:51], v3 offset:13056
    ds_read_b64_tr_b16 v[32:33], v6 offset:6144
    v_mfma_f32_16x16x32_bf16 v[132:135], v[12:15], v[64:67], v[132:135]
    s_nop 0
    ds_read_b64_tr_b16 v[34:35], v5 offset:6912
    ds_read_b64_tr_b16 v[52:53], v5 offset:12288
    ds_read_b64_tr_b16 v[54:55], v6 offset:13056
    v_mfma_f32_16x16x32_bf16 v[156:159], v[12:15], v[76:79], v[156:159]
    s_waitcnt lgkmcnt(15)
    ds_read_b64_tr_b16 v[56:57], v6 offset:12288
    ds_read_b64_tr_b16 v[58:59], v5 offset:13056
    v_cvt_pk_bf16_f32 v111, v114, v115
    v_mfma_f32_16x16x32_bf16 v[136:139], v[16:19], v[64:67], v[136:139]
    v_permlane16_swap_b32 v108, v110
    v_permlane16_swap_b32 v109, v111
    v_mfma_f32_16x16x32_bf16 v[160:163], v[16:19], v[76:79], v[160:163]
    s_waitcnt lgkmcnt(15)
    buffer_store_dwordx4 v[108:111], v88, s[16:19], s47 offen sc0 sc1
    v_cvt_pk_bf16_f32 v116, v116, v117
    v_cvt_pk_bf16_f32 v117, v118, v119
    v_mfma_f32_16x16x32_bf16 v[140:143], v[20:23], v[64:67], v[140:143]
    v_cvt_pk_bf16_f32 v118, v120, v121
    v_cvt_pk_bf16_f32 v119, v122, v123
    v_mfma_f32_16x16x32_bf16 v[164:167], v[20:23], v[76:79], v[164:167]
    s_waitcnt lgkmcnt(10)
    v_permlane16_swap_b32 v116, v118
    v_permlane16_swap_b32 v117, v119
    v_mfma_f32_16x16x32_bf16 v[144:147], v[24:27], v[64:67], v[144:147]
    s_waitcnt lgkmcnt(8)
    buffer_store_dwordx4 v[116:119], v89, s[16:19], s47 offen sc0 sc1
    v_cvt_pk_bf16_f32 v124, v124, v125
    v_cvt_pk_bf16_f32 v125, v126, v127
    v_mfma_f32_16x16x32_bf16 v[148:151], v[28:31], v[64:67], v[148:151]
    s_waitcnt lgkmcnt(4)
    v_cvt_pk_bf16_f32 v126, v128, v129
    v_cvt_pk_bf16_f32 v127, v130, v131
    v_mfma_f32_16x16x32_bf16 v[152:155], v[32:35], v[64:67], v[152:155]
    v_permlane16_swap_b32 v124, v126
    v_permlane16_swap_b32 v125, v127
    v_mfma_f32_16x16x32_bf16 v[132:135], v[36:39], v[68:71], v[132:135]
    v_mfma_f32_16x16x32_bf16 v[156:159], v[36:39], v[80:83], v[156:159]
    buffer_store_dwordx4 v[124:127], v90, s[16:19], s47 offen sc0 sc1
    v_mfma_f32_16x16x32_bf16 v[136:139], v[40:43], v[68:71], v[136:139]
    v_mfma_f32_16x16x32_bf16 v[160:163], v[40:43], v[80:83], v[160:163]
    v_mfma_f32_16x16x32_bf16 v[140:143], v[44:47], v[68:71], v[140:143]
    v_mfma_f32_16x16x32_bf16 v[164:167], v[44:47], v[80:83], v[164:167]
    v_mfma_f32_16x16x32_bf16 v[144:147], v[48:51], v[68:71], v[144:147]
    s_waitcnt lgkmcnt(2)
    v_mfma_f32_16x16x32_bf16 v[148:151], v[52:55], v[68:71], v[148:151]
    s_waitcnt lgkmcnt(0)
    v_mfma_f32_16x16x32_bf16 v[152:155], v[56:59], v[68:71], v[152:155]
    v_mov_b32 v40, v88
    v_mov_b32 v41, v89
    v_mov_b32 v42, v90
    v_mov_b32 v43, v91
    s_branch L_eT
L_n14:
    s_cmp_lt_u32 s24, 9
    s_cbranch_scc1 L_n12
    ds_read_b128 v[36:39], v8 offset:0
    ds_read_b128 v[48:51], v9 offset:0
    ds_read_b128 v[60:63], v10 offset:0
    s_waitcnt lgkmcnt(0)
.p2align 6
L_F12:
    s_waitcnt lgkmcnt(8)
    v_mfma_f32_16x16x32_bf16 v[84:87], v[12:15], v[36:39], v[84:87]
    ds_read_b64_tr_b16 v[32:33], v2 offset:128
    s_add_u32 s40, s40, 1
    v_mfma_f32_16x16x32_bf16 v[108:111], v[12:15], v[48:51], v[108:111]
    ds_read_b64_tr_b16 v[34:35], v1 offset:896
    s_cmp_eq_u32 s40, 3
    v_mfma_f32_16x16x32_bf16 v[132:135], v[12:15], v[60:63], v[132:135]
    s_waitcnt lgkmcnt(8)
    ds_read_b128 v[40:43], v8 offset:64
    v_mfma_f32_16x16x32_bf16 v[88:91], v[16:19], v[36:39], v[88:91]
    s_cselect_b32 s41, s43, s44
    ds_read_b64_tr_b16 v[12:13], v1 offset:6144
    s_cselect_b32 s40, 0, s40
    v_mfma_f32_16x16x32_bf16 v[112:115], v[16:19], v[48:51], v[112:115]
    ds_read_b64_tr_b16 v[14:15], v2 offset:6912
    v_mfma_f32_16x16x32_bf16 v[136:139], v[16:19], v[60:63], v[136:139]
    s_waitcnt lgkmcnt(9)
    ds_read_b128 v[52:55], v9 offset:64
    v_mfma_f32_16x16x32_bf16 v[92:95], v[20:23], v[36:39], v[92:95]
    ds_read_b64_tr_b16 v[16:17], v2 offset:6144
    v_mfma_f32_16x16x32_bf16 v[116:119], v[20:23], v[48:51], v[116:119]
    ds_read_b64_tr_b16 v[18:19], v1 offset:6912
    v_mfma_f32_16x16x32_bf16 v[140:143], v[20:23], v[60:63], v[140:143]
    s_waitcnt lgkmcnt(10)
    ds_read_b128 v[64:67], v10 offset:64
    v_mfma_f32_16x16x32_bf16 v[96:99], v[24:27], v[36:39], v[96:99]
    ds_read_b64_tr_b16 v[20:21], v1 offset:6208
    v_mfma_f32_16x16x32_bf16 v[120:123], v[24:27], v[48:51], v[120:123]
    ds_read_b64_tr_b16 v[22:23], v2 offset:6976
    v_mfma_f32_16x16x32_bf16 v[144:147], v[24:27], v[60:63], v[144:147]
    s_waitcnt lgkmcnt(11)
    ds_read_b128 v[44:47], v8 offset:128
    v_mfma_f32_16x16x32_bf16 v[100:103], v[28:31], v[36:39], v[100:103]
    ds_read_b64_tr_b16 v[24:25], v2 offset:6208
    v_mfma_f32_16x16x32_bf16 v[124:127], v[28:31], v[48:51], v[124:127]
    ds_read_b64_tr_b16 v[26:27], v1 offset:6976
    v_mfma_f32_16x16x32_bf16 v[148:151], v[28:31], v[60:63], v[148:151]
    s_waitcnt lgkmcnt(12)
    ds_read_b128 v[56:59], v9 offset:128
    v_mfma_f32_16x16x32_bf16 v[104:107], v[32:35], v[36:39], v[104:107]
    ds_read_b64_tr_b16 v[28:29], v1 offset:6272
    v_mfma_f32_16x16x32_bf16 v[128:131], v[32:35], v[48:51], v[128:131]
    ds_read_b64_tr_b16 v[30:31], v2 offset:7040
    v_mfma_f32_16x16x32_bf16 v[152:155], v[32:35], v[60:63], v[152:155]
    s_waitcnt lgkmcnt(12)
    ds_read_b128 v[68:71], v10 offset:128
    v_mfma_f32_16x16x32_bf16 v[84:87], v[12:15], v[40:43], v[84:87]
    s_waitcnt lgkmcnt(12)
    ds_read_b64_tr_b16 v[32:33], v2 offset:6272
    v_mfma_f32_16x16x32_bf16 v[108:111], v[12:15], v[52:55], v[108:111]
    s_waitcnt lgkmcnt(10)
    ds_read_b64_tr_b16 v[34:35], v1 offset:7040
    v_mfma_f32_16x16x32_bf16 v[132:135], v[12:15], v[64:67], v[132:135]
    ds_read_b128 v[8:11], v0 offset:0
    v_xor_b32 v0, 0x100, v0
    v_mfma_f32_16x16x32_bf16 v[88:91], v[16:19], v[40:43], v[88:91]
    ds_read_b64_tr_b16 v[72:73], v1 offset:12288
    v_mfma_f32_16x16x32_bf16 v[112:115], v[16:19], v[52:55], v[112:115]
    ds_read_b64_tr_b16 v[74:75], v2 offset:13056
    v_mfma_f32_16x16x32_bf16 v[136:139], v[16:19], v[64:67], v[136:139]
    s_waitcnt lgkmcnt(12)
    ds_read_b64_tr_b16 v[76:77], v2 offset:12288
    v_mfma_f32_16x16x32_bf16 v[92:95], v[20:23], v[40:43], v[92:95]
    ds_read_b64_tr_b16 v[78:79], v1 offset:13056
    v_mfma_f32_16x16x32_bf16 v[116:119], v[20:23], v[52:55], v[116:119]
    ds_read_b64_tr_b16 v[80:81], v1 offset:12352
    v_mfma_f32_16x16x32_bf16 v[140:143], v[20:23], v[64:67], v[140:143]
    s_waitcnt lgkmcnt(12)
    ds_read_b64_tr_b16 v[82:83], v2 offset:13120
    v_mfma_f32_16x16x32_bf16 v[96:99], v[24:27], v[40:43], v[96:99]
    ds_read_b64_tr_b16 v[156:157], v2 offset:12352
    v_mfma_f32_16x16x32_bf16 v[120:123], v[24:27], v[52:55], v[120:123]
    ds_read_b64_tr_b16 v[158:159], v1 offset:13120
    v_mfma_f32_16x16x32_bf16 v[144:147], v[24:27], v[64:67], v[144:147]
    s_waitcnt lgkmcnt(12)
    ds_read_b64_tr_b16 v[160:161], v1 offset:12416
    v_mfma_f32_16x16x32_bf16 v[100:103], v[28:31], v[40:43], v[100:103]
    ds_read_b64_tr_b16 v[162:163], v2 offset:13184
    v_mfma_f32_16x16x32_bf16 v[124:127], v[28:31], v[52:55], v[124:127]
    ds_read_b64_tr_b16 v[164:165], v2 offset:12416
    v_mfma_f32_16x16x32_bf16 v[148:151], v[28:31], v[64:67], v[148:151]
    s_waitcnt lgkmcnt(12)
    ds_read_b64_tr_b16 v[166:167], v1 offset:13184
    v_add_u32 v1, s41, v1
    v_mfma_f32_16x16x32_bf16 v[104:107], v[32:35], v[40:43], v[104:107]
    s_waitcnt lgkmcnt(12)
    v_bitop3_b32 v9, v9, s49, v7 bitop3:0x6a
    v_add_u32 v2, s41, v2
    v_mfma_f32_16x16x32_bf16 v[128:131], v[32:35], v[52:55], v[128:131]
    v_bitop3_b32 v10, v10, s49, v7 bitop3:0x6a
    v_mfma_f32_16x16x32_bf16 v[152:155], v[32:35], v[64:67], v[152:155]
    s_waitcnt lgkmcnt(10)
    v_readfirstlane_b32 s42, v8
    v_mfma_f32_16x16x32_bf16 v[84:87], v[72:75], v[44:47], v[84:87]
    v_bitop3_b32 v8, v8, s49, v7 bitop3:0x6a
    v_mfma_f32_16x16x32_bf16 v[108:111], v[72:75], v[56:59], v[108:111]
    v_mfma_f32_16x16x32_bf16 v[132:135], v[72:75], v[68:71], v[132:135]
    s_waitcnt lgkmcnt(8)
    v_mfma_f32_16x16x32_bf16 v[88:91], v[76:79], v[44:47], v[88:91]
    v_mfma_f32_16x16x32_bf16 v[112:115], v[76:79], v[56:59], v[112:115]
    s_waitcnt lgkmcnt(0)
    s_barrier
    ds_read_b128 v[36:39], v8 offset:0
    v_mfma_f32_16x16x32_bf16 v[136:139], v[76:79], v[68:71], v[136:139]
    ds_read_b128 v[48:51], v9 offset:0
    v_mfma_f32_16x16x32_bf16 v[92:95], v[80:83], v[44:47], v[92:95]
    ds_read_b128 v[60:63], v10 offset:0
    v_mfma_f32_16x16x32_bf16 v[116:119], v[80:83], v[56:59], v[116:119]
    ds_read_b64_tr_b16 v[12:13], v1 offset:0
    v_mfma_f32_16x16x32_bf16 v[140:143], v[80:83], v[68:71], v[140:143]
    ds_read_b64_tr_b16 v[14:15], v2 offset:768
    v_mfma_f32_16x16x32_bf16 v[96:99], v[156:159], v[44:47], v[96:99]
    ds_read_b64_tr_b16 v[16:17], v2 offset:0
    v_mfma_f32_16x16x32_bf16 v[120:123], v[156:159], v[56:59], v[120:123]
    ds_read_b64_tr_b16 v[18:19], v1 offset:768
    v_mfma_f32_16x16x32_bf16 v[144:147], v[156:159], v[68:71], v[144:147]
    ds_read_b64_tr_b16 v[20:21], v1 offset:64
    v_mfma_f32_16x16x32_bf16 v[100:103], v[160:163], v[44:47], v[100:103]
    ds_read_b64_tr_b16 v[22:23], v2 offset:832
    v_mfma_f32_16x16x32_bf16 v[124:127], v[160:163], v[56:59], v[124:127]
    ds_read_b64_tr_b16 v[24:25], v2 offset:64
    v_mfma_f32_16x16x32_bf16 v[148:151], v[160:163], v[68:71], v[148:151]
    ds_read_b64_tr_b16 v[26:27], v1 offset:832
    v_mfma_f32_16x16x32_bf16 v[104:107], v[164:167], v[44:47], v[104:107]
    ds_read_b64_tr_b16 v[28:29], v1 offset:128
    v_mfma_f32_16x16x32_bf16 v[128:131], v[164:167], v[56:59], v[128:131]
    s_bitcmp1_b32 s42, 0
    ds_read_b64_tr_b16 v[30:31], v2 offset:896
    v_mfma_f32_16x16x32_bf16 v[152:155], v[164:167], v[68:71], v[152:155]
    s_cbranch_scc0 L_F12
    s_waitcnt lgkmcnt(0)
    v_mbcnt_lo_u32_b32 v36, -1, 0
    s_lshl_b32 s50, s56, 7
    v_mbcnt_hi_u32_b32 v36, -1, v36
    s_lshl_b32 s51, s56, 5
    v_and_b32 v37, 15, v36
    v_lshrrev_b32 v38, 1, v36
    v_mul_u32_u24 v37, 192, v37
    v_lshlrev_b32 v39, 1, v36
    v_and_b32 v38, 24, v38
    v_and_b32 v39, 32, v39
    s_lshl_b32 s52, s21, 9
    v_and_b32 v38, 16, v38
    s_add_u32 s52, s52, 512
    v_lshl_add_u32 v43, v36, 3, s52
    v_add3_u32 v37, v37, v38, v39
    v_add_u32 v40, s50, v37
    v_xor_b32 v41, s51, v37
    v_subrev_u32 v42, s50, v37
    v_add_u32 v41, 64, v41
    v_add_u32 v42, 0x80, v42
    s_branch L_e2
L_n12:
    s_cmp_lt_u32 s24, 5
    s_cbranch_scc1 L_n8
    ds_read_b128 v[36:39], v8 offset:0
    ds_read_b128 v[48:51], v9 offset:0
    s_waitcnt lgkmcnt(0)
.p2align 6
L_F8:
    s_waitcnt lgkmcnt(10)
    v_mfma_f32_16x16x32_bf16 v[84:87], v[12:15], v[36:39], v[84:87]
    ds_read_b128 v[40:43], v8 offset:64
    v_mfma_f32_16x16x32_bf16 v[108:111], v[12:15], v[48:51], v[108:111]
    s_waitcnt lgkmcnt(9)
    ds_read_b64_tr_b16 v[12:13], v1 offset:6144
    ds_read_b64_tr_b16 v[14:15], v2 offset:6912
    v_mfma_f32_16x16x32_bf16 v[88:91], v[16:19], v[36:39], v[88:91]
    s_nop 0
    ds_read_b128 v[52:55], v9 offset:64
    ds_read_b64_tr_b16 v[60:61], v1 offset:12288
    v_mfma_f32_16x16x32_bf16 v[112:115], v[16:19], v[48:51], v[112:115]
    s_waitcnt lgkmcnt(11)
    ds_read_b64_tr_b16 v[62:63], v2 offset:13056
    ds_read_b64_tr_b16 v[16:17], v2 offset:6144
    v_mfma_f32_16x16x32_bf16 v[92:95], v[20:23], v[36:39], v[92:95]
    s_add_u32 s40, s40, 1
    ds_read_b128 v[44:47], v8 offset:128
    ds_read_b64_tr_b16 v[18:19], v1 offset:6912
    v_mfma_f32_16x16x32_bf16 v[116:119], v[20:23], v[48:51], v[116:119]
    s_waitcnt lgkmcnt(13)
    ds_read_b64_tr_b16 v[64:65], v2 offset:12288
    ds_read_b64_tr_b16 v[66:67], v1 offset:13056
    v_mfma_f32_16x16x32_bf16 v[96:99], v[24:27], v[36:39], v[96:99]
    s_cmp_eq_u32 s40, 3
    ds_read_b128 v[56:59], v9 offset:128
    ds_read_b128 v[8:11], v0 offset:0
    v_mfma_f32_16x16x32_bf16 v[120:123], v[24:27], v[48:51], v[120:123]
    s_waitcnt lgkmcnt(15)
    v_xor_b32 v0, 0x100, v0
    s_cselect_b32 s41, s43, s44
    v_mfma_f32_16x16x32_bf16 v[100:103], v[28:31], v[36:39], v[100:103]
    s_cselect_b32 s40, 0, s40
    ds_read_b64_tr_b16 v[20:21], v1 offset:6208
    ds_read_b64_tr_b16 v[22:23], v2 offset:6976
    v_mfma_f32_16x16x32_bf16 v[124:127], v[28:31], v[48:51], v[124:127]
    s_waitcnt lgkmcnt(15)
    ds_read_b64_tr_b16 v[68:69], v1 offset:12352
    ds_read_b64_tr_b16 v[70:71], v2 offset:13120
    v_mfma_f32_16x16x32_bf16 v[104:107], v[32:35], v[36:39], v[104:107]
    s_nop 0
    ds_read_b64_tr_b16 v[24:25], v2 offset:6208
    ds_read_b64_tr_b16 v[26:27], v1 offset:6976
    v_mfma_f32_16x16x32_bf16 v[128:131], v[32:35], v[48:51], v[128:131]
    s_waitcnt lgkmcnt(15)
    ds_read_b64_tr_b16 v[72:73], v2 offset:12352
    ds_read_b64_tr_b16 v[74:75], v1 offset:13120
    v_mfma_f32_16x16x32_bf16 v[84:87], v[12:15], v[40:43], v[84:87]
    s_nop 0
    ds_read_b64_tr_b16 v[28:29], v1 offset:6272
    ds_read_b64_tr_b16 v[30:31], v2 offset:7040
    v_mfma_f32_16x16x32_bf16 v[108:111], v[12:15], v[52:55], v[108:111]
    s_waitcnt lgkmcnt(14)
    ds_read_b64_tr_b16 v[76:77], v1 offset:12416
    ds_read_b64_tr_b16 v[78:79], v2 offset:13184
    v_mfma_f32_16x16x32_bf16 v[88:91], v[16:19], v[40:43], v[88:91]
    s_waitcnt lgkmcnt(12)
    v_bitop3_b32 v9, v9, s49, v7 bitop3:0x6a
    v_mfma_f32_16x16x32_bf16 v[112:115], v[16:19], v[52:55], v[112:115]
    s_waitcnt lgkmcnt(10)
    v_readfirstlane_b32 s42, v8
    v_mfma_f32_16x16x32_bf16 v[92:95], v[20:23], v[40:43], v[92:95]
    v_bitop3_b32 v8, v8, s49, v7 bitop3:0x6a
    v_mfma_f32_16x16x32_bf16 v[116:119], v[20:23], v[52:55], v[116:119]
    s_waitcnt lgkmcnt(6)
    ds_read_b64_tr_b16 v[32:33], v2 offset:6272
    ds_read_b64_tr_b16 v[34:35], v1 offset:7040
    v_mfma_f32_16x16x32_bf16 v[96:99], v[24:27], v[40:43], v[96:99]
    s_nop 0
    ds_read_b64_tr_b16 v[80:81], v2 offset:12416
    ds_read_b64_tr_b16 v[82:83], v1 offset:13184
    v_mfma_f32_16x16x32_bf16 v[120:123], v[24:27], v[52:55], v[120:123]
    s_waitcnt lgkmcnt(6)
    v_add_u32 v1, s41, v1
    v_add_u32 v2, s41, v2
    v_mfma_f32_16x16x32_bf16 v[100:103], v[28:31], v[40:43], v[100:103]
    v_mfma_f32_16x16x32_bf16 v[124:127], v[28:31], v[52:55], v[124:127]
    s_waitcnt lgkmcnt(2)
    v_mfma_f32_16x16x32_bf16 v[104:107], v[32:35], v[40:43], v[104:107]
    v_mfma_f32_16x16x32_bf16 v[128:131], v[32:35], v[52:55], v[128:131]
    v_mfma_f32_16x16x32_bf16 v[84:87], v[60:63], v[44:47], v[84:87]
    v_mfma_f32_16x16x32_bf16 v[108:111], v[60:63], v[56:59], v[108:111]
    v_mfma_f32_16x16x32_bf16 v[88:91], v[64:67], v[44:47], v[88:91]
    s_waitcnt lgkmcnt(0)
    s_barrier
    ds_read_b128 v[36:39], v8 offset:0
    v_mfma_f32_16x16x32_bf16 v[112:115], v[64:67], v[56:59], v[112:115]
    s_nop 0
    ds_read_b128 v[48:51], v9 offset:0
    ds_read_b64_tr_b16 v[12:13], v1 offset:0
    v_mfma_f32_16x16x32_bf16 v[92:95], v[68:71], v[44:47], v[92:95]
    s_nop 0
    ds_read_b64_tr_b16 v[14:15], v2 offset:768
    ds_read_b64_tr_b16 v[16:17], v2 offset:0
    v_mfma_f32_16x16x32_bf16 v[116:119], v[68:71], v[56:59], v[116:119]
    s_nop 0
    ds_read_b64_tr_b16 v[18:19], v1 offset:768
    ds_read_b64_tr_b16 v[20:21], v1 offset:64
    v_mfma_f32_16x16x32_bf16 v[96:99], v[72:75], v[44:47], v[96:99]
    s_nop 0
    ds_read_b64_tr_b16 v[22:23], v2 offset:832
    ds_read_b64_tr_b16 v[24:25], v2 offset:64
    v_mfma_f32_16x16x32_bf16 v[120:123], v[72:75], v[56:59], v[120:123]
    s_nop 0
    ds_read_b64_tr_b16 v[26:27], v1 offset:832
    ds_read_b64_tr_b16 v[28:29], v1 offset:128
    v_mfma_f32_16x16x32_bf16 v[100:103], v[76:79], v[44:47], v[100:103]
    s_nop 0
    ds_read_b64_tr_b16 v[30:31], v2 offset:896
    ds_read_b64_tr_b16 v[32:33], v2 offset:128
    v_mfma_f32_16x16x32_bf16 v[124:127], v[76:79], v[56:59], v[124:127]
    ds_read_b64_tr_b16 v[34:35], v1 offset:896
    v_mfma_f32_16x16x32_bf16 v[104:107], v[80:83], v[44:47], v[104:107]
    s_bitcmp1_b32 s42, 0
    v_mfma_f32_16x16x32_bf16 v[128:131], v[80:83], v[56:59], v[128:131]
    s_cbranch_scc0 L_F8
    s_waitcnt lgkmcnt(0)
    v_mbcnt_lo_u32_b32 v36, -1, 0
    s_lshl_b32 s50, s56, 7
    v_mbcnt_hi_u32_b32 v36, -1, v36
    s_lshl_b32 s51, s56, 5
    v_and_b32 v37, 15, v36
    v_lshrrev_b32 v38, 1, v36
    v_mul_u32_u24 v37, 192, v37
    v_lshlrev_b32 v39, 1, v36
    v_and_b32 v38, 24, v38
    v_and_b32 v39, 32, v39
    s_lshl_b32 s52, s21, 9
    v_and_b32 v38, 16, v38
    s_add_u32 s52, s52, 512
    v_lshl_add_u32 v43, v36, 3, s52
    v_add3_u32 v37, v37, v38, v39
    v_add_u32 v40, s50, v37
    v_xor_b32 v41, s51, v37
    v_subrev_u32 v42, s50, v37
    v_add_u32 v41, 64, v41
    v_add_u32 v42, 0x80, v42
    s_branch L_e1
L_n8:
    ds_read_b128 v[36:39], v8 offset:0
    ds_read_b128 v[40:43], v8 offset:64
    ds_read_b128 v[44:47], v8 offset:128
    ds_read_b64_tr_b16 v[60:61], v1 offset:6144
    ds_read_b64_tr_b16 v[62:63], v2 offset:6912
    ds_read_b64_tr_b16 v[64:65], v2 offset:6144
    ds_read_b64_tr_b16 v[66:67], v1 offset:6912
    ds_read_b64_tr_b16 v[68:69], v1 offset:6208
    ds_read_b64_tr_b16 v[70:71], v2 offset:6976
    ds_read_b64_tr_b16 v[72:73], v2 offset:6208
    ds_read_b64_tr_b16 v[74:75], v1 offset:6976
    ds_read_b64_tr_b16 v[76:77], v1 offset:6272
    ds_read_b64_tr_b16 v[78:79], v2 offset:7040
    ds_read_b64_tr_b16 v[80:81], v2 offset:6272
    ds_read_b64_tr_b16 v[82:83], v1 offset:7040
    ds_read_b64_tr_b16 v[132:133], v1 offset:12288
    ds_read_b64_tr_b16 v[134:135], v2 offset:13056
    ds_read_b64_tr_b16 v[136:137], v2 offset:12288
    ds_read_b64_tr_b16 v[138:139], v1 offset:13056
    ds_read_b64_tr_b16 v[140:141], v1 offset:12352
    ds_read_b64_tr_b16 v[142:143], v2 offset:13120
    ds_read_b64_tr_b16 v[144:145], v2 offset:12352
    ds_read_b64_tr_b16 v[146:147], v1 offset:13120
    ds_read_b64_tr_b16 v[148:149], v1 offset:12416
    ds_read_b64_tr_b16 v[150:151], v2 offset:13184
    ds_read_b64_tr_b16 v[152:153], v2 offset:12416
    ds_read_b64_tr_b16 v[154:155], v1 offset:13184
    s_waitcnt lgkmcnt(0)
.p2align 6
L_F4:
    s_waitcnt lgkmcnt(15)
    v_mfma_f32_16x16x32_bf16 v[84:87], v[12:15], v[36:39], v[84:87]
    ds_read_b128 v[8:11], v0 offset:0
    v_xor_b32 v0, 0x100, v0
    s_add_u32 s40, s40, 1
    v_mfma_f32_16x16x32_bf16 v[88:91], v[16:19], v[36:39], v[88:91]
    s_cmp_eq_u32 s40, 3
    s_cselect_b32 s41, s43, s44
    s_cselect_b32 s40, 0, s40
    v_mfma_f32_16x16x32_bf16 v[92:95], v[20:23], v[36:39], v[92:95]
    v_add_u32 v1, s41, v1
    v_add_u32 v2, s41, v2
    v_mfma_f32_16x16x32_bf16 v[96:99], v[24:27], v[36:39], v[96:99]
    v_mfma_f32_16x16x32_bf16 v[100:103], v[28:31], v[36:39], v[100:103]
    v_mfma_f32_16x16x32_bf16 v[104:107], v[32:35], v[36:39], v[104:107]
    v_mfma_f32_16x16x32_bf16 v[84:87], v[60:63], v[40:43], v[84:87]
    v_mfma_f32_16x16x32_bf16 v[88:91], v[64:67], v[40:43], v[88:91]
    v_mfma_f32_16x16x32_bf16 v[92:95], v[68:71], v[40:43], v[92:95]
    s_waitcnt lgkmcnt(0)
    v_readfirstlane_b32 s42, v8
    v_mfma_f32_16x16x32_bf16 v[96:99], v[72:75], v[40:43], v[96:99]
    v_bitop3_b32 v8, v8, s49, v7 bitop3:0x6a
    v_mfma_f32_16x16x32_bf16 v[100:103], v[76:79], v[40:43], v[100:103]
    s_barrier
    ds_read_b128 v[36:39], v8 offset:0
    v_mfma_f32_16x16x32_bf16 v[104:107], v[80:83], v[40:43], v[104:107]
    s_nop 0
    ds_read_b128 v[40:43], v8 offset:64
    ds_read_b64_tr_b16 v[12:13], v1 offset:0
    ds_read_b64_tr_b16 v[14:15], v2 offset:768
    v_mfma_f32_16x16x32_bf16 v[84:87], v[132:135], v[44:47], v[84:87]
    s_nop 0
    ds_read_b64_tr_b16 v[16:17], v2 offset:0
    ds_read_b64_tr_b16 v[18:19], v1 offset:768
    ds_read_b64_tr_b16 v[20:21], v1 offset:64
    v_mfma_f32_16x16x32_bf16 v[88:91], v[136:139], v[44:47], v[88:91]
    s_nop 0
    ds_read_b64_tr_b16 v[22:23], v2 offset:832
    ds_read_b64_tr_b16 v[24:25], v2 offset:64
    ds_read_b64_tr_b16 v[26:27], v1 offset:832
    v_mfma_f32_16x16x32_bf16 v[92:95], v[140:143], v[44:47], v[92:95]
    s_nop 0
    ds_read_b64_tr_b16 v[28:29], v1 offset:128
    ds_read_b64_tr_b16 v[30:31], v2 offset:896
    ds_read_b64_tr_b16 v[32:33], v2 offset:128
    v_mfma_f32_16x16x32_bf16 v[96:99], v[144:147], v[44:47], v[96:99]
    s_nop 0
    ds_read_b64_tr_b16 v[34:35], v1 offset:896
    ds_read_b64_tr_b16 v[60:61], v1 offset:6144
    ds_read_b64_tr_b16 v[62:63], v2 offset:6912
    v_mfma_f32_16x16x32_bf16 v[100:103], v[148:151], v[44:47], v[100:103]
    s_bitcmp1_b32 s42, 0
    ds_read_b64_tr_b16 v[64:65], v2 offset:6144
    ds_read_b64_tr_b16 v[66:67], v1 offset:6912
    ds_read_b64_tr_b16 v[68:69], v1 offset:6208
    v_mfma_f32_16x16x32_bf16 v[104:107], v[152:155], v[44:47], v[104:107]
    s_nop 0
    ds_read_b128 v[44:47], v8 offset:128
    ds_read_b64_tr_b16 v[70:71], v2 offset:6976
    ds_read_b64_tr_b16 v[72:73], v2 offset:6208
    ds_read_b64_tr_b16 v[74:75], v1 offset:6976
    ds_read_b64_tr_b16 v[76:77], v1 offset:6272
    ds_read_b64_tr_b16 v[78:79], v2 offset:7040
    ds_read_b64_tr_b16 v[80:81], v2 offset:6272
    ds_read_b64_tr_b16 v[82:83], v1 offset:7040
    ds_read_b64_tr_b16 v[132:133], v1 offset:12288
    ds_read_b64_tr_b16 v[134:135], v2 offset:13056
    ds_read_b64_tr_b16 v[136:137], v2 offset:12288
    ds_read_b64_tr_b16 v[138:139], v1 offset:13056
    ds_read_b64_tr_b16 v[140:141], v1 offset:12352
    ds_read_b64_tr_b16 v[142:143], v2 offset:13120
    ds_read_b64_tr_b16 v[144:145], v2 offset:12352
    ds_read_b64_tr_b16 v[146:147], v1 offset:13120
    ds_read_b64_tr_b16 v[148:149], v1 offset:12416
    ds_read_b64_tr_b16 v[150:151], v2 offset:13184
    ds_read_b64_tr_b16 v[152:153], v2 offset:12416
    ds_read_b64_tr_b16 v[154:155], v1 offset:13184
    s_cbranch_scc0 L_F4
    s_waitcnt lgkmcnt(0)
    v_mbcnt_lo_u32_b32 v36, -1, 0
    s_lshl_b32 s50, s56, 7
    v_mbcnt_hi_u32_b32 v36, -1, v36
    s_lshl_b32 s51, s56, 5
    v_and_b32 v37, 15, v36
    v_lshrrev_b32 v38, 1, v36
    v_mul_u32_u24 v37, 192, v37
    v_lshlrev_b32 v39, 1, v36
    v_and_b32 v38, 24, v38
    v_and_b32 v39, 32, v39
    s_lshl_b32 s52, s21, 9
    v_and_b32 v38, 16, v38
    s_add_u32 s52, s52, 512
    v_lshl_add_u32 v43, v36, 3, s52
    v_add3_u32 v37, v37, v38, v39
    v_add_u32 v40, s50, v37
    v_xor_b32 v41, s51, v37
    v_subrev_u32 v42, s50, v37
    v_add_u32 v41, 64, v41
    v_add_u32 v42, 0x80, v42
    s_branch L_e0
L_md:
    v_lshrrev_b32 v26, 1, v19
    v_lshlrev_b32 v3, 3, v23
    v_xor_b32 v26, v26, v19
    v_cmp_eq_u32 vcc, v19, v23
    v_mul_u32_u24 v24, 768, v19
    v_lshlrev_b32 v26, 5, v26
    s_lshl_b32 s29, s21, 11
    v_lshrrev_b32 v21, 2, v0
    s_add_u32 s29, s29, 155648
    v_and_b32 v26, 32, v26
    v_lshl_add_u32 v9, v21, 5, s29
    v_mov_b32 v10, 0x200
    s_lshl_b32 s29, s21, 9
    v_cndmask_b32 v9, 0, v9, vcc
    v_cndmask_b32 v10, 0, v10, vcc
    s_add_u32 s29, s29, 512
    v_add3_u32 v1, v24, v25, v26
    v_xor_b32 v8, 32, v3
    v_lshl_add_u32 v0, v21, 4, s29
    s_movk_i32 s58, 0x600
    v_xor_b32 v2, 32, v1
    s_waitcnt vmcnt(0)
    s_barrier
    ds_read_b32 v36, v37 offset:272
    ds_read_b128 v[72:75], v0 offset:0
    ds_read_b128 v[132:135], v9 offset:0
    ds_read_b128 v[136:139], v9 offset:16
    ds_read_b64_tr_b16 v[12:13], v1 offset:0
    ds_read_b64_tr_b16 v[14:15], v1 offset:3072
    ds_read_b64_tr_b16 v[16:17], v2 offset:0
    ds_read_b64_tr_b16 v[18:19], v2 offset:3072
    ds_read_b64_tr_b16 v[20:21], v1 offset:64
    ds_read_b64_tr_b16 v[22:23], v1 offset:3136
    ds_read_b64_tr_b16 v[24:25], v2 offset:64
    ds_read_b64_tr_b16 v[26:27], v2 offset:3136
    ds_read_b64_tr_b16 v[28:29], v1 offset:128
    ds_read_b64_tr_b16 v[30:31], v1 offset:3200
    ds_read_b64_tr_b16 v[32:33], v2 offset:128
    ds_read_b64_tr_b16 v[34:35], v2 offset:3200
    ds_read_b64_tr_b16 v[144:145], v1 offset:12288
    ds_read_b64_tr_b16 v[146:147], v1 offset:15360
    ds_read_b64_tr_b16 v[148:149], v2 offset:12288
    ds_read_b64_tr_b16 v[150:151], v2 offset:15360
    ds_read_b64_tr_b16 v[152:153], v1 offset:12352
    ds_read_b64_tr_b16 v[154:155], v1 offset:15424
    ds_read_b64_tr_b16 v[156:157], v2 offset:12352
    ds_read_b64_tr_b16 v[158:159], v2 offset:15424
    ds_read_b64_tr_b16 v[160:161], v1 offset:12416
    ds_read_b64_tr_b16 v[162:163], v1 offset:15488
    ds_read_b64_tr_b16 v[164:165], v2 offset:12416
    ds_read_b64_tr_b16 v[166:167], v2 offset:15488
    v_xor_b32 v0, 0x100, v0
    s_waitcnt lgkmcnt(15)
    v_readfirstlane_b32 s42, v72
    v_bitop3_b32 v76, v72, s49, v8 bitop3:0x6a
    v_bitop3_b32 v72, v72, s49, v3 bitop3:0x6a
    v_bitop3_b32 v77, v73, s49, v8 bitop3:0x6a
    v_bitop3_b32 v73, v73, s49, v3 bitop3:0x6a
    v_bitop3_b32 v78, v74, s49, v8 bitop3:0x6a
    v_bitop3_b32 v74, v74, s49, v3 bitop3:0x6a
    v_bitop3_b32 v79, v75, s49, v8 bitop3:0x6a
    v_bitop3_b32 v75, v75, s49, v3 bitop3:0x6a
    v_add_u32 v11, v10, v9
    v_bfi_b32 v9, s58, v11, v9
    v_readfirstlane_b32 s54, v36
    s_mul_i32 s55, s54, 196
    s_cmp_gt_u32 s55, s32
    s_barrier
    s_cbranch_scc1 L_rst2
    s_cmp_lt_u32 s24, 5
    s_cbranch_scc1 L_nd8
    ds_read_b64_tr_b16 v[36:37], v72 offset:0
    ds_read_b64_tr_b16 v[38:39], v73 offset:0
    ds_read_b64_tr_b16 v[140:141], v76 offset:0
    ds_read_b64_tr_b16 v[142:143], v77 offset:0
    ds_read_b64_tr_b16 v[48:49], v74 offset:0
    ds_read_b64_tr_b16 v[50:51], v75 offset:0
    ds_read_b64_tr_b16 v[4:5], v78 offset:0
    ds_read_b64_tr_b16 v[6:7], v79 offset:0
    ds_read_b64_tr_b16 v[40:41], v72 offset:64
    ds_read_b64_tr_b16 v[42:43], v73 offset:64
    ds_read_b64_tr_b16 v[60:61], v76 offset:64
    ds_read_b64_tr_b16 v[62:63], v77 offset:64
    ds_read_b64_tr_b16 v[52:53], v74 offset:64
    ds_read_b64_tr_b16 v[54:55], v75 offset:64
    ds_read_b64_tr_b16 v[64:65], v78 offset:64
    ds_read_b64_tr_b16 v[66:67], v79 offset:64
    s_waitcnt lgkmcnt(14)
    v_mfma_f32_16x16x32_bf16 v[36:39], v[36:39], v[132:135], 0
    s_waitcnt lgkmcnt(12)
    v_mfma_f32_16x16x32_bf16 v[140:143], v[140:143], v[132:135], 0
    s_waitcnt lgkmcnt(10)
    v_mfma_f32_16x16x32_bf16 v[48:51], v[48:51], v[136:139], 0
    s_waitcnt lgkmcnt(8)
    v_mfma_f32_16x16x32_bf16 v[4:7], v[4:7], v[136:139], 0
    s_nop 1
    v_cvt_pk_bf16_f32 v36, v36, v37
    v_cvt_pk_bf16_f32 v37, v38, v39
    v_cvt_pk_bf16_f32 v38, v140, v141
    v_cvt_pk_bf16_f32 v39, v142, v143
    v_cvt_pk_bf16_f32 v48, v48, v49
    v_cvt_pk_bf16_f32 v49, v50, v51
    v_cvt_pk_bf16_f32 v50, v4, v5
    v_cvt_pk_bf16_f32 v51, v6, v7
    s_waitcnt lgkmcnt(0)
.p2align 6
L_D8:
    s_waitcnt lgkmcnt(15)
    v_mfma_f32_16x16x32_bf16 v[40:43], v[40:43], v[132:135], 0
    s_add_u32 s40, s40, 1
    ds_read_b64_tr_b16 v[44:45], v72 offset:128
    ds_read_b64_tr_b16 v[46:47], v73 offset:128
    v_mfma_f32_16x16x32_bf16 v[60:63], v[60:63], v[132:135], 0
    s_waitcnt lgkmcnt(15)
    ds_read_b64_tr_b16 v[68:69], v76 offset:128
    ds_read_b64_tr_b16 v[70:71], v77 offset:128
    v_mfma_f32_16x16x32_bf16 v[52:55], v[52:55], v[136:139], 0
    s_waitcnt lgkmcnt(15)
    ds_read_b64_tr_b16 v[56:57], v74 offset:128
    ds_read_b64_tr_b16 v[58:59], v75 offset:128
    v_mfma_f32_16x16x32_bf16 v[64:67], v[64:67], v[136:139], 0
    s_waitcnt lgkmcnt(15)
    ds_read_b64_tr_b16 v[80:81], v78 offset:128
    v_cvt_pk_bf16_f32 v40, v40, v41
    v_mfma_f32_16x16x32_bf16 v[84:87], v[12:15], v[36:39], v[84:87]
    s_cmp_eq_u32 s40, 3
    ds_read_b64_tr_b16 v[82:83], v79 offset:128
    v_cvt_pk_bf16_f32 v41, v42, v43
    v_mfma_f32_16x16x32_bf16 v[108:111], v[12:15], v[48:51], v[108:111]
    s_waitcnt lgkmcnt(15)
    ds_read_b64_tr_b16 v[12:13], v1 offset:6144
    v_cvt_pk_bf16_f32 v42, v60, v61
    v_mfma_f32_16x16x32_bf16 v[88:91], v[16:19], v[36:39], v[88:91]
    s_cselect_b32 s41, s43, s44
    ds_read_b64_tr_b16 v[14:15], v1 offset:9216
    v_cvt_pk_bf16_f32 v43, v62, v63
    v_mfma_f32_16x16x32_bf16 v[112:115], v[16:19], v[48:51], v[112:115]
    s_waitcnt lgkmcnt(15)
    ds_read_b64_tr_b16 v[16:17], v2 offset:6144
    v_cvt_pk_bf16_f32 v52, v52, v53
    v_mfma_f32_16x16x32_bf16 v[92:95], v[20:23], v[36:39], v[92:95]
    s_cselect_b32 s40, 0, s40
    ds_read_b64_tr_b16 v[18:19], v2 offset:9216
    v_cvt_pk_bf16_f32 v53, v54, v55
    v_mfma_f32_16x16x32_bf16 v[116:119], v[20:23], v[48:51], v[116:119]
    s_waitcnt lgkmcnt(15)
    ds_read_b64_tr_b16 v[20:21], v1 offset:6208
    v_cvt_pk_bf16_f32 v54, v64, v65
    v_mfma_f32_16x16x32_bf16 v[96:99], v[24:27], v[36:39], v[96:99]
    ds_read_b64_tr_b16 v[22:23], v1 offset:9280
    v_cvt_pk_bf16_f32 v55, v66, v67
    v_mfma_f32_16x16x32_bf16 v[120:123], v[24:27], v[48:51], v[120:123]
    s_waitcnt lgkmcnt(15)
    ds_read_b64_tr_b16 v[24:25], v2 offset:6208
    ds_read_b64_tr_b16 v[26:27], v2 offset:9280
    v_mfma_f32_16x16x32_bf16 v[100:103], v[28:31], v[36:39], v[100:103]
    ds_read_b128 v[72:75], v0 offset:0
    v_xor_b32 v0, 0x100, v0
    v_mfma_f32_16x16x32_bf16 v[124:127], v[28:31], v[48:51], v[124:127]
    s_waitcnt lgkmcnt(15)
    ds_read_b64_tr_b16 v[28:29], v1 offset:6272
    ds_read_b64_tr_b16 v[30:31], v1 offset:9344
    v_mfma_f32_16x16x32_bf16 v[104:107], v[32:35], v[36:39], v[104:107]
    s_nop 0
    ds_read_b64_tr_b16 v[144:145], v1 offset:12288
    ds_read_b64_tr_b16 v[146:147], v1 offset:15360
    v_mfma_f32_16x16x32_bf16 v[128:131], v[32:35], v[48:51], v[128:131]
    s_nop 0
    ds_read_b64_tr_b16 v[32:33], v2 offset:6272
    ds_read_b64_tr_b16 v[34:35], v2 offset:9344
    v_mfma_f32_16x16x32_bf16 v[44:47], v[44:47], v[132:135], 0
    s_waitcnt lgkmcnt(15)
    ds_read_b64_tr_b16 v[148:149], v2 offset:12288
    ds_read_b64_tr_b16 v[150:151], v2 offset:15360
    v_mfma_f32_16x16x32_bf16 v[68:71], v[68:71], v[132:135], 0
    s_nop 0
    ds_read_b64_tr_b16 v[152:153], v1 offset:12352
    ds_read_b64_tr_b16 v[154:155], v1 offset:15424
    v_mfma_f32_16x16x32_bf16 v[56:59], v[56:59], v[136:139], 0
    ds_read_b64_tr_b16 v[156:157], v2 offset:12352
    s_waitcnt lgkmcnt(11)
    v_readfirstlane_b32 s42, v72
    v_mfma_f32_16x16x32_bf16 v[80:83], v[80:83], v[136:139], 0
    ds_read_b128 v[132:135], v9 offset:0
    v_bitop3_b32 v76, v72, s49, v8 bitop3:0x6a
    v_bitop3_b32 v72, v72, s49, v3 bitop3:0x6a
    v_mfma_f32_16x16x32_bf16 v[84:87], v[12:15], v[40:43], v[84:87]
    ds_read_b128 v[136:139], v9 offset:16
    v_bitop3_b32 v77, v73, s49, v8 bitop3:0x6a
    v_bitop3_b32 v73, v73, s49, v3 bitop3:0x6a
    v_mfma_f32_16x16x32_bf16 v[108:111], v[12:15], v[52:55], v[108:111]
    ds_read_b64_tr_b16 v[158:159], v2 offset:15424
    v_bitop3_b32 v78, v74, s49, v8 bitop3:0x6a
    v_bitop3_b32 v74, v74, s49, v3 bitop3:0x6a
    v_mfma_f32_16x16x32_bf16 v[88:91], v[16:19], v[40:43], v[88:91]
    ds_read_b64_tr_b16 v[160:161], v1 offset:12416
    v_bitop3_b32 v79, v75, s49, v8 bitop3:0x6a
    v_bitop3_b32 v75, v75, s49, v3 bitop3:0x6a
    v_mfma_f32_16x16x32_bf16 v[112:115], v[16:19], v[52:55], v[112:115]
    ds_read_b64_tr_b16 v[162:163], v1 offset:15488
    v_add_u32 v11, v10, v9
    v_cvt_pk_bf16_f32 v44, v44, v45
    v_mfma_f32_16x16x32_bf16 v[92:95], v[20:23], v[40:43], v[92:95]
    ds_read_b64_tr_b16 v[164:165], v2 offset:12416
    v_bfi_b32 v9, s58, v11, v9
    v_cvt_pk_bf16_f32 v45, v46, v47
    v_mfma_f32_16x16x32_bf16 v[116:119], v[20:23], v[52:55], v[116:119]
    ds_read_b64_tr_b16 v[166:167], v2 offset:15488
    v_cvt_pk_bf16_f32 v46, v68, v69
    v_cvt_pk_bf16_f32 v47, v70, v71
    v_mfma_f32_16x16x32_bf16 v[96:99], v[24:27], v[40:43], v[96:99]
    v_cvt_pk_bf16_f32 v56, v56, v57
    v_cvt_pk_bf16_f32 v57, v58, v59
    v_cvt_pk_bf16_f32 v58, v80, v81
    v_mfma_f32_16x16x32_bf16 v[120:123], v[24:27], v[52:55], v[120:123]
    s_waitcnt lgkmcnt(15)
    v_cvt_pk_bf16_f32 v59, v82, v83
    v_add_u32 v1, s41, v1
    v_add_u32 v2, s41, v2
    v_mfma_f32_16x16x32_bf16 v[100:103], v[28:31], v[40:43], v[100:103]
    v_mfma_f32_16x16x32_bf16 v[124:127], v[28:31], v[52:55], v[124:127]
    s_waitcnt lgkmcnt(12)
    v_mfma_f32_16x16x32_bf16 v[104:107], v[32:35], v[40:43], v[104:107]
    v_mfma_f32_16x16x32_bf16 v[128:131], v[32:35], v[52:55], v[128:131]
    s_waitcnt lgkmcnt(0)
    s_barrier
    ds_read_b64_tr_b16 v[36:37], v72 offset:0
    v_mfma_f32_16x16x32_bf16 v[84:87], v[144:147], v[44:47], v[84:87]
    s_nop 0
    ds_read_b64_tr_b16 v[38:39], v73 offset:0
    ds_read_b64_tr_b16 v[140:141], v76 offset:0
    v_mfma_f32_16x16x32_bf16 v[108:111], v[144:147], v[56:59], v[108:111]
    s_nop 0
    ds_read_b64_tr_b16 v[142:143], v77 offset:0
    ds_read_b64_tr_b16 v[48:49], v74 offset:0
    v_mfma_f32_16x16x32_bf16 v[88:91], v[148:151], v[44:47], v[88:91]
    s_nop 0
    ds_read_b64_tr_b16 v[50:51], v75 offset:0
    ds_read_b64_tr_b16 v[4:5], v78 offset:0
    v_mfma_f32_16x16x32_bf16 v[112:115], v[148:151], v[56:59], v[112:115]
    s_nop 0
    ds_read_b64_tr_b16 v[6:7], v79 offset:0
    ds_read_b64_tr_b16 v[40:41], v72 offset:64
    v_mfma_f32_16x16x32_bf16 v[92:95], v[152:155], v[44:47], v[92:95]
    s_nop 0
    ds_read_b64_tr_b16 v[42:43], v73 offset:64
    ds_read_b64_tr_b16 v[60:61], v76 offset:64
    v_mfma_f32_16x16x32_bf16 v[116:119], v[152:155], v[56:59], v[116:119]
    s_nop 0
    ds_read_b64_tr_b16 v[62:63], v77 offset:64
    ds_read_b64_tr_b16 v[52:53], v74 offset:64
    v_mfma_f32_16x16x32_bf16 v[96:99], v[156:159], v[44:47], v[96:99]
    s_waitcnt lgkmcnt(11)
    ds_read_b64_tr_b16 v[54:55], v75 offset:64
    ds_read_b64_tr_b16 v[64:65], v78 offset:64
    v_mfma_f32_16x16x32_bf16 v[36:39], v[36:39], v[132:135], 0
    s_waitcnt lgkmcnt(11)
    ds_read_b64_tr_b16 v[66:67], v79 offset:64
    ds_read_b64_tr_b16 v[12:13], v1 offset:0
    v_mfma_f32_16x16x32_bf16 v[140:143], v[140:143], v[132:135], 0
    s_waitcnt lgkmcnt(11)
    ds_read_b64_tr_b16 v[14:15], v1 offset:3072
    ds_read_b64_tr_b16 v[16:17], v2 offset:0
    v_mfma_f32_16x16x32_bf16 v[48:51], v[48:51], v[136:139], 0
    s_waitcnt lgkmcnt(11)
    ds_read_b64_tr_b16 v[18:19], v2 offset:3072
    ds_read_b64_tr_b16 v[20:21], v1 offset:64
    v_mfma_f32_16x16x32_bf16 v[4:7], v[4:7], v[136:139], 0
    ds_read_b64_tr_b16 v[22:23], v1 offset:3136
    v_cvt_pk_bf16_f32 v36, v36, v37
    v_mfma_f32_16x16x32_bf16 v[120:123], v[156:159], v[56:59], v[120:123]
    ds_read_b64_tr_b16 v[24:25], v2 offset:64
    v_cvt_pk_bf16_f32 v37, v38, v39
    v_mfma_f32_16x16x32_bf16 v[100:103], v[160:163], v[44:47], v[100:103]
    ds_read_b64_tr_b16 v[26:27], v2 offset:3136
    v_cvt_pk_bf16_f32 v38, v140, v141
    v_mfma_f32_16x16x32_bf16 v[124:127], v[160:163], v[56:59], v[124:127]
    ds_read_b64_tr_b16 v[28:29], v1 offset:128
    v_cvt_pk_bf16_f32 v39, v142, v143
    v_mfma_f32_16x16x32_bf16 v[104:107], v[164:167], v[44:47], v[104:107]
    s_bitcmp1_b32 s42, 0
    ds_read_b64_tr_b16 v[30:31], v1 offset:3200
    v_cvt_pk_bf16_f32 v48, v48, v49
    v_mfma_f32_16x16x32_bf16 v[128:131], v[164:167], v[56:59], v[128:131]
    s_nop 0
    ds_read_b64_tr_b16 v[32:33], v2 offset:128
    v_cvt_pk_bf16_f32 v49, v50, v51
    ds_read_b64_tr_b16 v[34:35], v2 offset:3200
    v_cvt_pk_bf16_f32 v50, v4, v5
    v_cvt_pk_bf16_f32 v51, v6, v7
    s_cbranch_scc0 L_D8
    s_waitcnt lgkmcnt(0)
    v_mbcnt_lo_u32_b32 v36, -1, 0
    s_lshl_b32 s50, s56, 7
    v_mbcnt_hi_u32_b32 v36, -1, v36
    s_lshl_b32 s51, s56, 5
    v_and_b32 v37, 3, v36
    v_bfe_u32 v38, v36, 2, 2
    v_lshl_add_u32 v37, v37, 2, v38
    v_lshrrev_b32 v38, 1, v36
    v_mul_u32_u24 v37, 192, v37
    v_lshlrev_b32 v39, 1, v36
    v_and_b32 v38, 24, v38
    v_and_b32 v39, 32, v39
    s_lshl_b32 s52, s21, 9
    v_and_b32 v38, 16, v38
    s_add_u32 s52, s52, 512
    v_lshl_add_u32 v43, v36, 3, s52
    v_add3_u32 v37, v37, v38, v39
    v_add_u32 v40, s50, v37
    v_xor_b32 v41, s51, v37
    v_subrev_u32 v42, s50, v37
    v_add_u32 v41, 64, v41
    v_add_u32 v42, 0x80, v42
    s_branch L_e1
L_nd8:
    ds_read_b64_tr_b16 v[36:37], v72 offset:0
    ds_read_b64_tr_b16 v[38:39], v73 offset:0
    ds_read_b64_tr_b16 v[48:49], v74 offset:0
    ds_read_b64_tr_b16 v[50:51], v75 offset:0
    ds_read_b64_tr_b16 v[52:53], v76 offset:0
    ds_read_b64_tr_b16 v[54:55], v77 offset:0
    ds_read_b64_tr_b16 v[56:57], v78 offset:0
    ds_read_b64_tr_b16 v[58:59], v79 offset:0
    ds_read_b64_tr_b16 v[40:41], v72 offset:64
    ds_read_b64_tr_b16 v[42:43], v73 offset:64
    ds_read_b64_tr_b16 v[60:61], v74 offset:64
    ds_read_b64_tr_b16 v[62:63], v75 offset:64
    ds_read_b64_tr_b16 v[64:65], v76 offset:64
    ds_read_b64_tr_b16 v[66:67], v77 offset:64
    ds_read_b64_tr_b16 v[68:69], v78 offset:64
    ds_read_b64_tr_b16 v[70:71], v79 offset:64
    ds_read_b64_tr_b16 v[108:109], v1 offset:6144
    ds_read_b64_tr_b16 v[110:111], v1 offset:9216
    ds_read_b64_tr_b16 v[112:113], v2 offset:6144
    ds_read_b64_tr_b16 v[114:115], v2 offset:9216
    ds_read_b64_tr_b16 v[116:117], v1 offset:6208
    ds_read_b64_tr_b16 v[118:119], v1 offset:9280
    ds_read_b64_tr_b16 v[120:121], v2 offset:6208
    ds_read_b64_tr_b16 v[122:123], v2 offset:9280
    ds_read_b64_tr_b16 v[124:125], v1 offset:6272
    ds_read_b64_tr_b16 v[126:127], v1 offset:9344
    ds_read_b64_tr_b16 v[128:129], v2 offset:6272
    ds_read_b64_tr_b16 v[130:131], v2 offset:9344
    s_waitcnt lgkmcnt(15)
    v_mfma_f32_16x16x32_bf16 v[36:39], v[36:39], v[132:135], 0
    v_mfma_f32_16x16x32_bf16 v[52:55], v[52:55], v[132:135], 0
    v_mfma_f32_16x16x32_bf16 v[36:39], v[48:51], v[136:139], v[36:39]
    v_mfma_f32_16x16x32_bf16 v[52:55], v[56:59], v[136:139], v[52:55]
    s_nop 6
    v_cvt_pk_bf16_f32 v36, v36, v37
    v_cvt_pk_bf16_f32 v37, v38, v39
    v_cvt_pk_bf16_f32 v38, v52, v53
    v_cvt_pk_bf16_f32 v39, v54, v55
    s_waitcnt lgkmcnt(0)
.p2align 6
L_D4:
    s_nop 0
    v_mfma_f32_16x16x32_bf16 v[84:87], v[12:15], v[36:39], v[84:87]
    s_add_u32 s40, s40, 1
    ds_read_b64_tr_b16 v[44:45], v72 offset:128
    ds_read_b64_tr_b16 v[46:47], v73 offset:128
    ds_read_b64_tr_b16 v[48:49], v74 offset:128
    v_mfma_f32_16x16x32_bf16 v[40:43], v[40:43], v[132:135], 0
    s_cmp_eq_u32 s40, 3
    ds_read_b64_tr_b16 v[50:51], v75 offset:128
    ds_read_b64_tr_b16 v[52:53], v76 offset:128
    ds_read_b64_tr_b16 v[54:55], v77 offset:128
    s_waitcnt lgkmcnt(15)
    v_mfma_f32_16x16x32_bf16 v[64:67], v[64:67], v[132:135], 0
    s_cselect_b32 s41, s43, s44
    ds_read_b64_tr_b16 v[56:57], v78 offset:128
    ds_read_b64_tr_b16 v[58:59], v79 offset:128
    ds_read_b128 v[72:75], v0 offset:0
    v_mfma_f32_16x16x32_bf16 v[88:91], v[16:19], v[36:39], v[88:91]
    v_xor_b32 v0, 0x100, v0
    s_cselect_b32 s40, 0, s40
    v_add_u32 v1, s41, v1
    v_mfma_f32_16x16x32_bf16 v[92:95], v[20:23], v[36:39], v[92:95]
    v_add_u32 v2, s41, v2
    v_mfma_f32_16x16x32_bf16 v[40:43], v[60:63], v[136:139], v[40:43]
    v_mfma_f32_16x16x32_bf16 v[64:67], v[68:71], v[136:139], v[64:67]
    v_mfma_f32_16x16x32_bf16 v[96:99], v[24:27], v[36:39], v[96:99]
    v_mfma_f32_16x16x32_bf16 v[100:103], v[28:31], v[36:39], v[100:103]
    s_nop 4
    v_cvt_pk_bf16_f32 v40, v40, v41
    v_cvt_pk_bf16_f32 v41, v42, v43
    v_mfma_f32_16x16x32_bf16 v[104:107], v[32:35], v[36:39], v[104:107]
    s_waitcnt lgkmcnt(7)
    v_cvt_pk_bf16_f32 v42, v64, v65
    v_cvt_pk_bf16_f32 v43, v66, v67
    v_mfma_f32_16x16x32_bf16 v[44:47], v[44:47], v[132:135], 0
    s_waitcnt lgkmcnt(3)
    s_waitcnt lgkmcnt(0)
    v_readfirstlane_b32 s42, v72
    v_mfma_f32_16x16x32_bf16 v[52:55], v[52:55], v[132:135], 0
    v_bitop3_b32 v76, v72, s49, v8 bitop3:0x6a
    v_bitop3_b32 v72, v72, s49, v3 bitop3:0x6a
    v_bitop3_b32 v77, v73, s49, v8 bitop3:0x6a
    v_mfma_f32_16x16x32_bf16 v[84:87], v[108:111], v[40:43], v[84:87]
    v_bitop3_b32 v73, v73, s49, v3 bitop3:0x6a
    v_bitop3_b32 v78, v74, s49, v8 bitop3:0x6a
    v_bitop3_b32 v74, v74, s49, v3 bitop3:0x6a
    v_mfma_f32_16x16x32_bf16 v[88:91], v[112:115], v[40:43], v[88:91]
    v_bitop3_b32 v79, v75, s49, v8 bitop3:0x6a
    v_bitop3_b32 v75, v75, s49, v3 bitop3:0x6a
    v_mfma_f32_16x16x32_bf16 v[44:47], v[48:51], v[136:139], v[44:47]
    s_barrier
    ds_read_b64_tr_b16 v[12:13], v1 offset:0
    ds_read_b64_tr_b16 v[14:15], v1 offset:3072
    ds_read_b64_tr_b16 v[16:17], v2 offset:0
    v_mfma_f32_16x16x32_bf16 v[52:55], v[56:59], v[136:139], v[52:55]
    s_nop 0
    ds_read_b128 v[132:135], v9 offset:0
    ds_read_b128 v[136:139], v9 offset:16
    v_add_u32 v11, v10, v9
    v_mfma_f32_16x16x32_bf16 v[92:95], v[116:119], v[40:43], v[92:95]
    v_bfi_b32 v9, s58, v11, v9
    v_mfma_f32_16x16x32_bf16 v[96:99], v[120:123], v[40:43], v[96:99]
    v_cvt_pk_bf16_f32 v44, v44, v45
    v_cvt_pk_bf16_f32 v45, v46, v47
    v_mfma_f32_16x16x32_bf16 v[100:103], v[124:127], v[40:43], v[100:103]
    v_cvt_pk_bf16_f32 v46, v52, v53
    v_cvt_pk_bf16_f32 v47, v54, v55
    v_mfma_f32_16x16x32_bf16 v[104:107], v[128:131], v[40:43], v[104:107]
    s_nop 0
    ds_read_b64_tr_b16 v[36:37], v72 offset:0
    ds_read_b64_tr_b16 v[38:39], v73 offset:0
    ds_read_b64_tr_b16 v[48:49], v74 offset:0
    v_mfma_f32_16x16x32_bf16 v[84:87], v[144:147], v[44:47], v[84:87]
    s_nop 0
    ds_read_b64_tr_b16 v[50:51], v75 offset:0
    ds_read_b64_tr_b16 v[52:53], v76 offset:0
    ds_read_b64_tr_b16 v[54:55], v77 offset:0
    v_mfma_f32_16x16x32_bf16 v[88:91], v[148:151], v[44:47], v[88:91]
    s_nop 0
    ds_read_b64_tr_b16 v[56:57], v78 offset:0
    ds_read_b64_tr_b16 v[58:59], v79 offset:0
    ds_read_b64_tr_b16 v[40:41], v72 offset:64
    v_mfma_f32_16x16x32_bf16 v[92:95], v[152:155], v[44:47], v[92:95]
    s_nop 0
    ds_read_b64_tr_b16 v[42:43], v73 offset:64
    ds_read_b64_tr_b16 v[60:61], v74 offset:64
    ds_read_b64_tr_b16 v[62:63], v75 offset:64
    v_mfma_f32_16x16x32_bf16 v[96:99], v[156:159], v[44:47], v[96:99]
    s_nop 0
    ds_read_b64_tr_b16 v[64:65], v76 offset:64
    ds_read_b64_tr_b16 v[66:67], v77 offset:64
    ds_read_b64_tr_b16 v[68:69], v78 offset:64
    v_mfma_f32_16x16x32_bf16 v[100:103], v[160:163], v[44:47], v[100:103]
    s_bitcmp1_b32 s42, 0
    ds_read_b64_tr_b16 v[70:71], v79 offset:64
    ds_read_b64_tr_b16 v[18:19], v2 offset:3072
    ds_read_b64_tr_b16 v[20:21], v1 offset:64
    v_mfma_f32_16x16x32_bf16 v[104:107], v[164:167], v[44:47], v[104:107]
    s_nop 0
    ds_read_b64_tr_b16 v[22:23], v1 offset:3136
    ds_read_b64_tr_b16 v[24:25], v2 offset:64
    ds_read_b64_tr_b16 v[26:27], v2 offset:3136
    ds_read_b64_tr_b16 v[28:29], v1 offset:128
    ds_read_b64_tr_b16 v[30:31], v1 offset:3200
    ds_read_b64_tr_b16 v[32:33], v2 offset:128
    ds_read_b64_tr_b16 v[34:35], v2 offset:3200
    s_waitcnt lgkmcnt(15)
    ds_read_b64_tr_b16 v[108:109], v1 offset:6144
    ds_read_b64_tr_b16 v[110:111], v1 offset:9216
    ds_read_b64_tr_b16 v[112:113], v2 offset:6144
    ds_read_b64_tr_b16 v[114:115], v2 offset:9216
    v_mfma_f32_16x16x32_bf16 v[36:39], v[36:39], v[132:135], 0
    s_nop 0
    ds_read_b64_tr_b16 v[116:117], v1 offset:6208
    ds_read_b64_tr_b16 v[118:119], v1 offset:9280
    ds_read_b64_tr_b16 v[120:121], v2 offset:6208
    v_mfma_f32_16x16x32_bf16 v[52:55], v[52:55], v[132:135], 0
    s_nop 0
    ds_read_b64_tr_b16 v[122:123], v2 offset:9280
    ds_read_b64_tr_b16 v[124:125], v1 offset:6272
    ds_read_b64_tr_b16 v[126:127], v1 offset:9344
    ds_read_b64_tr_b16 v[128:129], v2 offset:6272
    ds_read_b64_tr_b16 v[130:131], v2 offset:9344
    ds_read_b64_tr_b16 v[144:145], v1 offset:12288
    ds_read_b64_tr_b16 v[146:147], v1 offset:15360
    ds_read_b64_tr_b16 v[148:149], v2 offset:12288
    ds_read_b64_tr_b16 v[150:151], v2 offset:15360
    ds_read_b64_tr_b16 v[152:153], v1 offset:12352
    ds_read_b64_tr_b16 v[154:155], v1 offset:15424
    v_mfma_f32_16x16x32_bf16 v[36:39], v[48:51], v[136:139], v[36:39]
    s_nop 0
    ds_read_b64_tr_b16 v[156:157], v2 offset:12352
    ds_read_b64_tr_b16 v[158:159], v2 offset:15424
    ds_read_b64_tr_b16 v[160:161], v1 offset:12416
    v_mfma_f32_16x16x32_bf16 v[52:55], v[56:59], v[136:139], v[52:55]
    s_nop 0
    ds_read_b64_tr_b16 v[162:163], v1 offset:15488
    ds_read_b64_tr_b16 v[164:165], v2 offset:12416
    ds_read_b64_tr_b16 v[166:167], v2 offset:15488
    v_cvt_pk_bf16_f32 v36, v36, v37
    v_cvt_pk_bf16_f32 v37, v38, v39
    s_nop 1
    v_cvt_pk_bf16_f32 v38, v52, v53
    v_cvt_pk_bf16_f32 v39, v54, v55
    s_cbranch_scc0 L_D4
    s_waitcnt lgkmcnt(0)
    v_mbcnt_lo_u32_b32 v36, -1, 0
    s_lshl_b32 s50, s56, 7
    v_mbcnt_hi_u32_b32 v36, -1, v36
    s_lshl_b32 s51, s56, 5
    v_and_b32 v37, 3, v36
    v_bfe_u32 v38, v36, 2, 2
    v_lshl_add_u32 v37, v37, 2, v38
    v_lshrrev_b32 v38, 1, v36
    v_mul_u32_u24 v37, 192, v37
    v_lshlrev_b32 v39, 1, v36
    v_and_b32 v38, 24, v38
    v_and_b32 v39, 32, v39
    s_lshl_b32 s52, s21, 9
    v_and_b32 v38, 16, v38
    s_add_u32 s52, s52, 512
    v_lshl_add_u32 v43, v36, 3, s52
    v_add3_u32 v37, v37, v38, v39
    v_add_u32 v40, s50, v37
    v_xor_b32 v41, s51, v37
    v_subrev_u32 v42, s50, v37
    v_add_u32 v41, 64, v41
    v_add_u32 v42, 0x80, v42
    s_branch L_e0
L_fix:
    s_sub_u32 s56, m0, s28
    s_sub_u32 s50, s50, 43008
    s_add_u32 s54, s25, s30
    s_mul_i32 s57, s30, s28
    s_mul_i32 s54, s54, 43008
    s_add_u32 s57, s57, s51
    v_lshlrev_b32 v21, 4, v0
    s_mov_b32 s12, s92
    s_and_b32 s13, s93, 0xffff
    s_mov_b32 s14, 460800
    s_mov_b32 s15, 0x00020000
    s_lshl_b32 s63, s21, 5
    s_add_u32 s63, s63, s39
    s_lshl_b32 s63, s63, 10
    v_mov_b32 v30, 0
    s_mul_i32 s68, s21, 22400
    s_mul_i32 s36, s22, 22400
    s_mul_i32 s37, s23, 100
    s_lshr_b32 s71, s21, 1
    s_add_u32 s36, s36, s37
    s_mul_i32 s71, s71, 22400
    s_sub_u32 s70, s36, s68
    s_add_u32 s68, s68, s36
    s_add_u32 s71, s71, s36
    s_add_u32 s69, s70, 156800
    s_add_u32 s70, s70, 246400
    s_add_u32 s71, s71, 268800
    s_mov_b32 s8, s90
    s_and_b32 s9, s91, 0xffff
    s_mov_b32 s10, 5017600
    s_mov_b32 s11, 0x00020000
    v_cvt_f32_u32 v34, s25
    v_cvt_f32_u32 v33, s26
    s_mov_b32 s80, 0x04010401
    v_add_f32 v34, -0.5, v34
    v_add_f32 v33, -0.5, v33
    s_lshl_b32 s64, s21, 2
    v_cvt_pk_bf16_f32 v39, v34, v33
    s_add_u32 s64, s64, 256
    v_and_b32 v39, 0x7f807f80, v39
    v_mov_b32 v31, s64
    v_pk_sub_u16 v39, v39, s80 clamp
    s_waitcnt vmcnt(0)
    s_barrier
    s_barrier
    s_add_u32 s56, s56, s28
    s_add_u32 s50, s50, 43008
    s_min_u32 m0, s56, s57
    s_min_u32 s50, s50, s54
    s_mov_b64 exec, s[52:53]
    buffer_load_dwordx4 v20, s[4:7], s50 offen nt lds
    s_mov_b64 exec, -1
    s_add_u32 s56, s56, s28
    s_add_u32 s50, s50, 43008
    s_min_u32 m0, s56, s57
    s_min_u32 s50, s50, s54
    s_mov_b64 exec, s[52:53]
    buffer_load_dwordx4 v20, s[4:7], s50 offen nt lds
    s_mov_b64 exec, -1
    s_add_u32 s56, s56, s28
    s_add_u32 s50, s50, 43008
    s_min_u32 m0, s56, s57
    s_min_u32 s50, s50, s54
    s_mov_b64 exec, s[52:53]
    buffer_load_dwordx4 v20, s[4:7], s50 offen nt lds
    s_mov_b64 exec, -1
    s_add_u32 s56, s56, s28
    s_add_u32 s50, s50, 43008
    s_min_u32 m0, s56, s57
    s_min_u32 s50, s50, s54
    s_mov_b64 exec, s[52:53]
    buffer_load_dwordx4 v20, s[4:7], s50 offen nt lds
    s_mov_b64 exec, -1
    s_add_u32 s56, s56, s28
    s_add_u32 s50, s50, 43008
    s_min_u32 m0, s56, s57
    s_min_u32 s50, s50, s54
    s_mov_b64 exec, s[52:53]
    buffer_load_dwordx4 v20, s[4:7], s50 offen nt lds
    s_mov_b64 exec, -1
    s_add_u32 s56, s56, s28
    s_add_u32 s50, s50, 43008
    s_min_u32 m0, s56, s57
    s_min_u32 s50, s50, s54
    s_mov_b64 exec, s[52:53]
    buffer_load_dwordx4 v20, s[4:7], s50 offen nt lds
    s_mov_b64 exec, -1
    s_add_u32 s56, s56, s28
    s_add_u32 s50, s50, 43008
    s_min_u32 m0, s56, s57
    s_min_u32 s50, s50, s54
    s_mov_b64 exec, s[52:53]
    buffer_load_dwordx4 v20, s[4:7], s50 offen nt lds
    s_mov_b64 exec, -1
    s_barrier
    s_waitcnt vmcnt(1)
    s_barrier
    s_barrier
    s_add_u32 s63, s63, 131072
    buffer_load_dwordx4 v[16:19], v21, s[12:15], s63 offen
    s_barrier
    buffer_load_dwordx4 v[40:43], v21, s[8:11], s68 offen nt
    s_mov_b32 exec_hi, 15
    buffer_load_dwordx4 v[56:59], v21, s[8:11], s68 offen offset:1024 nt
    s_mov_b32 exec_hi, -1
    s_waitcnt vmcnt(3)
    s_barrier
    buffer_load_dwordx4 v[44:47], v21, s[8:11], s69 offen nt
    s_mov_b32 exec_hi, 15
    buffer_load_dwordx4 v[60:63], v21, s[8:11], s69 offen offset:1024 nt
    s_mov_b32 exec_hi, -1
    s_barrier
    buffer_load_dwordx4 v[48:51], v21, s[8:11], s70 offen nt
    s_mov_b32 exec_hi, 15
    buffer_load_dwordx4 v[64:67], v21, s[8:11], s70 offen offset:1024 nt
    s_mov_b32 exec_hi, -1
    s_barrier
    buffer_load_dwordx4 v[52:55], v21, s[8:11], s71 offen nt
    s_mov_b32 exec_hi, 15
    buffer_load_dwordx4 v[68:71], v21, s[8:11], s71 offen offset:1024 nt
    s_mov_b32 exec_hi, -1
    s_add_u32 s56, s56, s28
    s_add_u32 s50, s50, 43008
    s_min_u32 m0, s56, s57
    s_min_u32 s50, s50, s54
    s_mov_b64 exec, s[52:53]
    buffer_load_dwordx4 v20, s[4:7], s50 offen nt lds
    s_mov_b64 exec, -1
    s_barrier
    s_barrier
    s_waitcnt vmcnt(0)
    v_pk_maximum3_f16 v36, v40, v41, v39
    v_pk_minimum3_f16 v37, v40, v41, v41
    v_pk_maximum3_f16 v36, v42, v43, v36
    v_pk_minimum3_f16 v37, v42, v43, v37
    v_pk_maximum3_f16 v36, v44, v45, v36
    v_pk_minimum3_f16 v37, v44, v45, v37
    v_pk_maximum3_f16 v36, v46, v47, v36
    v_pk_minimum3_f16 v37, v46, v47, v37
    v_pk_maximum3_f16 v36, v48, v49, v36
    v_pk_minimum3_f16 v37, v48, v49, v37
    v_pk_maximum3_f16 v36, v50, v51, v36
    v_pk_minimum3_f16 v37, v50, v51, v37
    v_pk_maximum3_f16 v36, v52, v53, v36
    v_pk_minimum3_f16 v37, v52, v53, v37
    v_pk_maximum3_f16 v36, v54, v55, v36
    v_pk_minimum3_f16 v37, v54, v55, v37
    s_mov_b32 exec_hi, 15
    v_pk_maximum3_f16 v36, v56, v57, v36
    v_pk_minimum3_f16 v37, v56, v57, v37
    v_pk_maximum3_f16 v36, v58, v59, v36
    v_pk_minimum3_f16 v37, v58, v59, v37
    v_pk_maximum3_f16 v36, v60, v61, v36
    v_pk_minimum3_f16 v37, v60, v61, v37
    v_pk_maximum3_f16 v36, v62, v63, v36
    v_pk_minimum3_f16 v37, v62, v63, v37
    v_pk_maximum3_f16 v36, v64, v65, v36
    v_pk_minimum3_f16 v37, v64, v65, v37
    v_pk_maximum3_f16 v36, v66, v67, v36
    v_pk_minimum3_f16 v37, v66, v67, v37
    v_pk_maximum3_f16 v36, v68, v69, v36
    v_pk_minimum3_f16 v37, v68, v69, v37
    v_pk_maximum3_f16 v36, v70, v71, v36
    v_pk_minimum3_f16 v37, v70, v71, v37
    s_mov_b32 exec_hi, -1
    v_pk_maximum3_f16 v36, v37, v36, v36 neg_lo:[1,0,0] neg_hi:[1,0,0]
    v_cmp_ne_u32 vcc, v36, v39
    s_cmp_lg_u64 vcc, 0
    s_cselect_b32 s64, 1, 0
    v_mov_b32 v36, s64
    ds_write_b32 v31, v36
    s_waitcnt lgkmcnt(0)
    s_barrier
    ds_read_b128 v[32:35], v30 offset:256
    s_waitcnt lgkmcnt(0)
    v_or3_b32 v32, v32, v33, v34
    v_or_b32 v32, v32, v35
    v_cmp_ne_u32 vcc, 0, v32
    s_cmp_lg_u64 vcc, 0
    s_cbranch_scc1 L_fixr
    s_add_u32 s56, s56, s28
    s_add_u32 s50, s50, 43008
    s_min_u32 m0, s56, s57
    s_min_u32 s50, s50, s54
    s_mov_b64 exec, s[52:53]
    buffer_load_dwordx4 v20, s[4:7], s50 offen nt lds
    s_mov_b64 exec, -1
    s_add_u32 s63, s63, 131072
    buffer_load_dwordx4 v[16:19], v21, s[12:15], s63 offen
    s_barrier
    s_add_u32 s56, s56, s28
    s_add_u32 s50, s50, 43008
    s_min_u32 m0, s56, s57
    s_min_u32 s50, s50, s54
    s_mov_b64 exec, s[52:53]
    buffer_load_dwordx4 v20, s[4:7], s50 offen nt lds
    s_mov_b64 exec, -1
    s_barrier
    s_add_u32 s63, s63, 131072
    buffer_load_dwordx4 v[16:19], v21, s[12:15], s63 offen
    s_barrier
    s_branch L_bexit
L_fixr:
    s_waitcnt vmcnt(0)
    s_barrier
    s_barrier
    s_branch L_rst
L_fixg:
    s_setprio 3
    s_add_u32 s29, s30, 1
    s_mul_i32 s34, s29, s28
    s_lshl_b32 s29, s27, 13
    s_add_u32 s34, s34, 57856
    s_sub_u32 s32, 163056, s29
    s_sub_u32 s32, s32, s34
    v_lshlrev_b32 v21, 4, v0
    s_mov_b32 s12, s92
    s_and_b32 s13, s93, 0xffff
    s_mov_b32 s14, 460800
    s_mov_b32 s15, 0x00020000
    s_sub_u32 s33, 159232, s34
    s_lshr_b32 s33, s33, 9
    s_mul_i32 s33, s33, 171
    s_lshr_b32 s33, s33, 9
    s_min_u32 s33, s33, 32
    s_andn2_b32 s33, s33, 1
    s_mul_i32 s29, s33, 192
    s_add_u32 s29, s29, 64
    s_mul_i32 s58, s29, s21
    s_add_u32 s58, s58, s34
    s_lshl_b32 s29, s29, 2
    s_lshl_b32 s59, s58, 1
    s_add_u32 s59, s59, s29
    v_lshrrev_b32 v26, 4, v0
    v_and_b32 v27, 3, v0
    v_bfe_u32 v28, v0, 2, 2
    v_lshlrev_b32 v10, 4, v26
    v_lshlrev_b32 v5, 4, v27
    v_lshrrev_b32 v29, 5, v0
    v_lshl_add_u32 v6, v29, 3, v5
    v_lshl_add_u32 v29, v27, 2, v28
    s_lshl_b32 s64, s21, 10
    s_add_u32 s64, s64, 159744
    s_add_u32 s65, s64, 512
    s_xor_b32 s65, s65, s64
    v_lshl_add_u32 v4, v29, 4, s64
    v_lshrrev_b32 v30, 2, v0
    v_lshl_add_u32 v2, v30, 4, s64
    v_and_b32 v30, 7, v30
    v_lshl_add_u32 v3, v30, 4, s64
    s_sub_u32 s64, s33, 16
    v_cmp_gt_u32 s[40:41], s64, v29
    v_and_b32 v31, 7, v29
    v_cmp_gt_u32 s[42:43], s64, v31
    v_mul_u32_u24 v29, 192, v29
    v_xor_b32 v30, v26, v27
    v_lshl_add_u32 v7, v30, 4, v29
    v_mul_u32_u24 v31, 192, v31
    v_and_b32 v30, 1, v27
    v_xor_b32 v30, v26, v30
    v_lshl_add_u32 v31, v30, 4, v31
    v_lshrrev_b32 v30, 1, v27
    v_lshl_add_u32 v8, v30, 3, v31
    s_lshl_b32 s64, s21, 9
    s_add_u32 s64, s64, 512
    v_mov_b32 v1, s64
    v_and_b32 v29, 1, v28
    v_lshrrev_b32 v30, 1, v28
    v_mov_b32 v31, 0x05040100
    v_mov_b32 v32, 0x01000c0c
    v_cmp_eq_u32 vcc, 1, v29
    v_mov_b32 v33, 0x07060302
    v_mov_b32 v34, 0x03020c0c
    v_cmp_eq_u32 s[44:45], v27, v26
    v_cndmask_b32 v31, v31, v32, vcc
    v_cndmask_b32 v33, v33, v34, vcc
    v_cmp_eq_u32 s[46:47], 0, v30
    v_mov_b32 v32, 0x0c0c0c0c
    s_andn2_b64 s[48:49], s[44:45], s[46:47]
    s_and_b64 s[46:47], s[44:45], s[46:47]
    v_cndmask_b32 v12, v32, v31, s[46:47]
    v_cndmask_b32 v13, v32, v31, s[48:49]
    v_cndmask_b32 v14, v32, v33, s[46:47]
    v_cndmask_b32 v15, v32, v33, s[48:49]
    s_lshl_b32 s64, s21, 2
    s_add_u32 s64, s64, 288
    v_mov_b32 v29, s64
    v_mov_b32 v30, 0
    s_mov_b32 s62, 0
    s_mov_b32 s66, 0x12
    s_mov_b32 s96, 0
    s_bitcmp1_b32 s2, 31
    s_cbranch_scc0 L_bs
    s_barrier
    ds_read_b32 v11, v29
    s_waitcnt lgkmcnt(0)
    v_readfirstlane_b32 s60, v11
    s_waitcnt vmcnt(0)
    s_bitcmp1_b32 s60, 17
    s_barrier
    s_cbranch_scc1 L_bstep
L_bclean:
    s_barrier
    s_add_u32 s50, s55, 43008
    s_sub_u32 s64, s35, s25
    s_sub_u32 s64, s64, 1
    s_min_u32 s64, s64, s30
    s_mul_i32 s64, s64, s28
    s_add_u32 m0, s64, s51
    s_add_u32 s54, s25, s30
    s_mul_i32 s54, s54, 43008
    s_mul_i32 s55, s30, s28
    s_add_u32 s55, s55, s51
    s_min_u32 s50, s50, s54
    s_mov_b64 exec, s[52:53]
    buffer_load_dwordx4 v20, s[4:7], s50 offen nt lds
    s_add_u32 m0, m0, s28
    s_add_u32 s50, s50, 43008
    s_min_u32 m0, m0, s55
    s_min_u32 s50, s50, s54
    buffer_load_dwordx4 v20, s[4:7], s50 offen nt lds
    s_add_u32 m0, m0, s28
    s_add_u32 s50, s50, 43008
    s_min_u32 m0, m0, s55
    s_min_u32 s50, s50, s54
    buffer_load_dwordx4 v20, s[4:7], s50 offen nt lds
    s_add_u32 m0, m0, s28
    s_add_u32 s50, s50, 43008
    s_min_u32 m0, m0, s55
    s_min_u32 s50, s50, s54
    buffer_load_dwordx4 v20, s[4:7], s50 offen nt lds
    s_mov_b64 exec, -1
    s_lshl_b32 s63, s21, 5
    s_add_u32 s63, s63, s39
    s_lshl_b32 s63, s63, 10
    s_add_u32 s63, s63, 131072
    buffer_load_dwordx4 v[16:19], v21, s[12:15], s63 offen
    s_add_u32 s63, s63, 131072
    buffer_load_dwordx4 v[16:19], v21, s[12:15], s63 offen
    s_add_u32 s63, s63, 131072
    buffer_load_dwordx4 v[16:19], v21, s[12:15], s63 offen
    s_barrier
    s_barrier
L_bexit:
    s_waitcnt vmcnt(0) lgkmcnt(0)
    s_endpgm
.p2align 6
L_bstep:
    ds_read_b32 v11, v1
    ds_read_b128 v[24:27], v2
    ds_read_b128 v[28:31], v3
    v_xor_b32 v1, 0x100, v1
    s_add_u32 s62, s62, 1
    s_min_u32 s62, s62, 31
    s_waitcnt lgkmcnt(2)
    v_readfirstlane_b32 s60, v11
    s_bfe_u32 s61, s60, 0x80012
    s_cbranch_scc1 L_B1
    s_bitcmp1_b32 s60, 0
    s_cbranch_scc1 L_bexit
L_bendS:
    v_xor_b32 v2, s65, v2
    v_xor_b32 v3, s65, v3
    s_sub_u32 s58, s59, s58
    s_bitcmp1_b32 s66, s62
    s_cbranch_scc1 L_bw
    s_waitcnt lgkmcnt(0)
    s_barrier
    s_branch L_bstep
L_bw:
    s_cmp_eq_u32 s62, 1
    s_cbranch_scc1 L_bw1
    s_waitcnt vmcnt(0) lgkmcnt(0)
    s_barrier
    s_branch L_bstep
L_bw1:
    s_waitcnt lgkmcnt(0)
    s_barrier
    s_add_u32 s50, s55, 43008
    s_sub_u32 s64, s35, s25
    s_sub_u32 s64, s64, 1
    s_min_u32 s64, s64, s30
    s_mul_i32 s64, s64, s28
    s_add_u32 m0, s64, s51
    s_add_u32 s54, s25, s30
    s_mul_i32 s54, s54, 43008
    s_mul_i32 s55, s30, s28
    s_add_u32 s55, s55, s51
    s_min_u32 s50, s50, s54
    s_mov_b64 exec, s[52:53]
    buffer_load_dwordx4 v20, s[4:7], s50 offen nt lds
    s_add_u32 m0, m0, s28
    s_add_u32 s50, s50, 43008
    s_min_u32 m0, m0, s55
    s_min_u32 s50, s50, s54
    buffer_load_dwordx4 v20, s[4:7], s50 offen nt lds
    s_add_u32 m0, m0, s28
    s_add_u32 s50, s50, 43008
    s_min_u32 m0, m0, s55
    s_min_u32 s50, s50, s54
    buffer_load_dwordx4 v20, s[4:7], s50 offen nt lds
    s_add_u32 m0, m0, s28
    s_add_u32 s50, s50, 43008
    s_min_u32 m0, m0, s55
    s_min_u32 s50, s50, s54
    buffer_load_dwordx4 v20, s[4:7], s50 offen nt lds
    s_mov_b64 exec, -1
    s_lshl_b32 s63, s21, 5
    s_add_u32 s63, s63, s39
    s_lshl_b32 s63, s63, 10
    s_add_u32 s63, s63, 131072
    buffer_load_dwordx4 v[16:19], v21, s[12:15], s63 offen
    s_add_u32 s63, s63, 131072
    buffer_load_dwordx4 v[16:19], v21, s[12:15], s63 offen
    s_add_u32 s63, s63, 131072
    buffer_load_dwordx4 v[16:19], v21, s[12:15], s63 offen
    s_branch L_bstep
L_B1:
    s_cmp_gt_u32 s61, 8
    s_cbranch_scc1 L_BF
    s_waitcnt lgkmcnt(0)
    v_xor_b32 v32, v28, v6
    v_xor_b32 v33, v29, v6
    ds_read_b64_tr_b16 v[56:57], v32 offset:0
    ds_read_b64_tr_b16 v[58:59], v33 offset:0
    v_perm_b32 v40, v31, v30, v12
    v_perm_b32 v41, v31, v30, v13
    ds_read_b64_tr_b16 v[60:61], v32 offset:64
    ds_read_b64_tr_b16 v[62:63], v33 offset:64
    v_perm_b32 v42, v31, v30, v14
    v_perm_b32 v43, v31, v30, v15
    ds_read_b64_tr_b16 v[64:65], v32 offset:128
    ds_read_b64_tr_b16 v[66:67], v33 offset:128
    v_add_u32 v9, s58, v8
    s_waitcnt lgkmcnt(4)
    v_mfma_f32_16x16x32_bf16 v[56:59], v[56:59], v[40:43], 0
    s_waitcnt lgkmcnt(2)
    v_mfma_f32_16x16x32_bf16 v[60:63], v[60:63], v[40:43], 0
    s_waitcnt lgkmcnt(0)
    v_mfma_f32_16x16x32_bf16 v[64:67], v[64:67], v[40:43], 0
    s_nop 3
    v_cvt_pk_bf16_f32 v56, v56, v57
    v_cvt_pk_bf16_f32 v57, v58, v59
    ds_write_b64 v9, v[56:57] offset:0
    v_cvt_pk_bf16_f32 v60, v60, v61
    v_cvt_pk_bf16_f32 v61, v62, v63
    ds_write_b64 v9, v[60:61] offset:64
    v_cvt_pk_bf16_f32 v64, v64, v65
    v_cvt_pk_bf16_f32 v65, v66, v67
    ds_write_b64 v9, v[64:65] offset:128
    s_branch L_bendS
L_BF:
    ds_read_b128 v[48:51], v2 offset:256
    ds_read_b128 v[52:55], v3 offset:256
    s_branch L_bd1
.p2align 6
L_bd:
    ds_read_b128 v[24:27], v2
    ds_read_b32 v11, v1
    ds_read_b128 v[48:51], v2 offset:256
    ds_read_b128 v[52:55], v3 offset:256
    v_xor_b32 v1, 0x100, v1
    s_add_u32 s62, s62, 1
    s_min_u32 s62, s62, 31
L_bd1:
    s_waitcnt lgkmcnt(3)
    v_xor_b32 v32, v24, v5
    v_xor_b32 v33, v25, v5
    ds_read_b64_tr_b16 v[56:57], v32 offset:0
    ds_read_b64_tr_b16 v[58:59], v33 offset:0
    s_waitcnt lgkmcnt(4)
    v_readfirstlane_b32 s60, v11
    ds_read_b64_tr_b16 v[60:61], v32 offset:8
    ds_read_b64_tr_b16 v[62:63], v33 offset:8
    v_perm_b32 v40, v27, v26, v12
    ds_read_b64_tr_b16 v[64:65], v32 offset:64
    ds_read_b64_tr_b16 v[66:67], v33 offset:64
    v_perm_b32 v41, v27, v26, v13
    s_bfe_u32 s61, s60, 0x80012
    ds_read_b64_tr_b16 v[68:69], v32 offset:72
    ds_read_b64_tr_b16 v[70:71], v33 offset:72
    v_perm_b32 v42, v27, v26, v14
    ds_read_b64_tr_b16 v[72:73], v32 offset:128
    ds_read_b64_tr_b16 v[74:75], v33 offset:128
    v_perm_b32 v43, v27, v26, v15
    s_cmp_gt_u32 s61, 16
    ds_read_b64_tr_b16 v[76:77], v32 offset:136
    ds_read_b64_tr_b16 v[78:79], v33 offset:136
    v_add_u32 v9, s58, v7
    s_cbranch_scc1 L_BFH
    s_waitcnt lgkmcnt(10)
    v_mfma_f32_16x16x32_bf16 v[56:59], v[56:59], v[40:43], 0
    s_waitcnt lgkmcnt(8)
    v_mfma_f32_16x16x32_bf16 v[60:63], v[60:63], v[40:43], 0
    s_waitcnt lgkmcnt(6)
    v_mfma_f32_16x16x32_bf16 v[64:67], v[64:67], v[40:43], 0
    s_waitcnt lgkmcnt(4)
    v_mfma_f32_16x16x32_bf16 v[68:71], v[68:71], v[40:43], 0
    s_waitcnt lgkmcnt(2)
    v_mfma_f32_16x16x32_bf16 v[72:75], v[72:75], v[40:43], 0
    v_cvt_pk_bf16_f32 v56, v56, v57
    v_cvt_pk_bf16_f32 v57, v58, v59
    s_waitcnt lgkmcnt(0)
    v_mfma_f32_16x16x32_bf16 v[76:79], v[76:79], v[40:43], 0
    v_cvt_pk_bf16_f32 v58, v60, v61
    v_cvt_pk_bf16_f32 v59, v62, v63
    ds_write_b128 v9, v[56:59] offset:0
    v_cvt_pk_bf16_f32 v64, v64, v65
    v_cvt_pk_bf16_f32 v65, v66, v67
    v_cvt_pk_bf16_f32 v66, v68, v69
    v_cvt_pk_bf16_f32 v67, v70, v71
    ds_write_b128 v9, v[64:67] offset:64
    v_cvt_pk_bf16_f32 v72, v72, v73
    v_cvt_pk_bf16_f32 v73, v74, v75
    v_cvt_pk_bf16_f32 v74, v76, v77
    v_cvt_pk_bf16_f32 v75, v78, v79
    ds_write_b128 v9, v[72:75] offset:128
L_bendD:
    v_xor_b32 v2, s65, v2
    v_xor_b32 v3, s65, v3
    s_sub_u32 s58, s59, s58
    s_bitcmp1_b32 s66, s62
    s_cbranch_scc1 L_bw
    s_bitcmp1_b32 s60, 0
    s_cbranch_scc1 L_bexit
    s_cmp_gt_u32 s61, 7
    s_waitcnt lgkmcnt(0)
    s_barrier
    s_cbranch_scc1 L_bd
    s_branch L_bstep
L_BFH:
    s_cmp_gt_u32 s61, 24
    s_cbranch_scc1 L_BFF
    s_waitcnt lgkmcnt(12)
    v_xor_b32 v34, v52, v6
    v_xor_b32 v35, v53, v6
    v_add_u32 v36, s58, v8
    ds_read_b64_tr_b16 v[80:81], v34 offset:0
    ds_read_b64_tr_b16 v[82:83], v35 offset:0
    s_waitcnt lgkmcnt(12)
    v_mfma_f32_16x16x32_bf16 v[56:59], v[56:59], v[40:43], 0
    v_perm_b32 v44, v55, v54, v12
    v_perm_b32 v45, v55, v54, v13
    ds_read_b64_tr_b16 v[84:85], v34 offset:64
    ds_read_b64_tr_b16 v[86:87], v35 offset:64
    s_waitcnt lgkmcnt(12)
    v_mfma_f32_16x16x32_bf16 v[60:63], v[60:63], v[40:43], 0
    v_perm_b32 v46, v55, v54, v14
    v_perm_b32 v47, v55, v54, v15
    ds_read_b64_tr_b16 v[88:89], v34 offset:128
    ds_read_b64_tr_b16 v[90:91], v35 offset:128
    s_waitcnt lgkmcnt(12)
    v_mfma_f32_16x16x32_bf16 v[64:67], v[64:67], v[40:43], 0
    s_waitcnt lgkmcnt(10)
    v_mfma_f32_16x16x32_bf16 v[68:71], v[68:71], v[40:43], 0
    s_waitcnt lgkmcnt(8)
    v_mfma_f32_16x16x32_bf16 v[72:75], v[72:75], v[40:43], 0
    s_waitcnt lgkmcnt(6)
    v_mfma_f32_16x16x32_bf16 v[76:79], v[76:79], v[40:43], 0
    v_cvt_pk_bf16_f32 v56, v56, v57
    v_cvt_pk_bf16_f32 v57, v58, v59
    s_waitcnt lgkmcnt(4)
    v_mfma_f32_16x16x32_bf16 v[80:83], v[80:83], v[44:47], 0
    v_cvt_pk_bf16_f32 v58, v60, v61
    v_cvt_pk_bf16_f32 v59, v62, v63
    ds_write_b128 v9, v[56:59] offset:0
    v_cvt_pk_bf16_f32 v64, v64, v65
    v_cvt_pk_bf16_f32 v65, v66, v67
    s_waitcnt lgkmcnt(3)
    v_mfma_f32_16x16x32_bf16 v[84:87], v[84:87], v[44:47], 0
    v_cvt_pk_bf16_f32 v66, v68, v69
    v_cvt_pk_bf16_f32 v67, v70, v71
    ds_write_b128 v9, v[64:67] offset:64
    v_cvt_pk_bf16_f32 v72, v72, v73
    v_cvt_pk_bf16_f32 v73, v74, v75
    s_waitcnt lgkmcnt(2)
    v_mfma_f32_16x16x32_bf16 v[88:91], v[88:91], v[44:47], 0
    v_cvt_pk_bf16_f32 v74, v76, v77
    v_cvt_pk_bf16_f32 v75, v78, v79
    ds_write_b128 v9, v[72:75] offset:128
    s_mov_b64 exec, s[42:43]
    v_cvt_pk_bf16_f32 v80, v80, v81
    v_cvt_pk_bf16_f32 v81, v82, v83
    ds_write_b64 v36, v[80:81] offset:3136
    v_cvt_pk_bf16_f32 v84, v84, v85
    v_cvt_pk_bf16_f32 v85, v86, v87
    ds_write_b64 v36, v[84:85] offset:3200
    v_cvt_pk_bf16_f32 v88, v88, v89
    v_cvt_pk_bf16_f32 v89, v90, v91
    ds_write_b64 v36, v[88:89] offset:3264
    s_mov_b64 exec, -1
    s_branch L_bendD
L_BFF:
    s_cmp_gt_u32 s61, 127
    s_cbranch_scc1 L_B3
    s_waitcnt lgkmcnt(13)
    v_xor_b32 v34, v48, v5
    v_xor_b32 v35, v49, v5
    ds_read_b64_tr_b16 v[80:81], v34 offset:0
    ds_read_b64_tr_b16 v[82:83], v35 offset:0
    s_waitcnt lgkmcnt(12)
    v_mfma_f32_16x16x32_bf16 v[56:59], v[56:59], v[40:43], 0
    v_perm_b32 v44, v51, v50, v12
    ds_read_b64_tr_b16 v[84:85], v34 offset:8
    ds_read_b64_tr_b16 v[86:87], v35 offset:8
    s_waitcnt lgkmcnt(12)
    v_mfma_f32_16x16x32_bf16 v[60:63], v[60:63], v[40:43], 0
    v_perm_b32 v45, v51, v50, v13
    ds_read_b64_tr_b16 v[88:89], v34 offset:64
    ds_read_b64_tr_b16 v[90:91], v35 offset:64
    s_waitcnt lgkmcnt(12)
    v_mfma_f32_16x16x32_bf16 v[64:67], v[64:67], v[40:43], 0
    v_perm_b32 v46, v51, v50, v14
    ds_read_b64_tr_b16 v[92:93], v34 offset:72
    ds_read_b64_tr_b16 v[94:95], v35 offset:72
    s_waitcnt lgkmcnt(12)
    v_mfma_f32_16x16x32_bf16 v[68:71], v[68:71], v[40:43], 0
    v_perm_b32 v47, v51, v50, v15
    ds_read_b64_tr_b16 v[96:97], v34 offset:128
    ds_read_b64_tr_b16 v[98:99], v35 offset:128
    s_waitcnt lgkmcnt(12)
    v_mfma_f32_16x16x32_bf16 v[72:75], v[72:75], v[40:43], 0
    ds_read_b64_tr_b16 v[100:101], v34 offset:136
    ds_read_b64_tr_b16 v[102:103], v35 offset:136
    s_waitcnt lgkmcnt(12)
    v_mfma_f32_16x16x32_bf16 v[76:79], v[76:79], v[40:43], 0
    s_waitcnt lgkmcnt(10)
    v_mfma_f32_16x16x32_bf16 v[80:83], v[80:83], v[44:47], 0
    v_cvt_pk_bf16_f32 v56, v56, v57
    v_cvt_pk_bf16_f32 v57, v58, v59
    s_waitcnt lgkmcnt(8)
    v_mfma_f32_16x16x32_bf16 v[84:87], v[84:87], v[44:47], 0
    v_cvt_pk_bf16_f32 v58, v60, v61
    v_cvt_pk_bf16_f32 v59, v62, v63
    ds_write_b128 v9, v[56:59] offset:0
    s_waitcnt lgkmcnt(7)
    v_mfma_f32_16x16x32_bf16 v[88:91], v[88:91], v[44:47], 0
    v_cvt_pk_bf16_f32 v64, v64, v65
    v_cvt_pk_bf16_f32 v65, v66, v67
    s_waitcnt lgkmcnt(5)
    v_mfma_f32_16x16x32_bf16 v[92:95], v[92:95], v[44:47], 0
    v_cvt_pk_bf16_f32 v66, v68, v69
    v_cvt_pk_bf16_f32 v67, v70, v71
    ds_write_b128 v9, v[64:67] offset:64
    s_waitcnt lgkmcnt(4)
    v_mfma_f32_16x16x32_bf16 v[96:99], v[96:99], v[44:47], 0
    v_cvt_pk_bf16_f32 v72, v72, v73
    v_cvt_pk_bf16_f32 v73, v74, v75
    s_waitcnt lgkmcnt(2)
    v_mfma_f32_16x16x32_bf16 v[100:103], v[100:103], v[44:47], 0
    v_cvt_pk_bf16_f32 v74, v76, v77
    v_cvt_pk_bf16_f32 v75, v78, v79
    ds_write_b128 v9, v[72:75] offset:128
    s_mov_b64 exec, s[40:41]
    v_cvt_pk_bf16_f32 v80, v80, v81
    v_cvt_pk_bf16_f32 v81, v82, v83
    v_cvt_pk_bf16_f32 v82, v84, v85
    v_cvt_pk_bf16_f32 v83, v86, v87
    ds_write_b128 v9, v[80:83] offset:3136
    v_cvt_pk_bf16_f32 v88, v88, v89
    v_cvt_pk_bf16_f32 v89, v90, v91
    v_cvt_pk_bf16_f32 v90, v92, v93
    v_cvt_pk_bf16_f32 v91, v94, v95
    ds_write_b128 v9, v[88:91] offset:3200
    v_cvt_pk_bf16_f32 v96, v96, v97
    v_cvt_pk_bf16_f32 v97, v98, v99
    v_cvt_pk_bf16_f32 v98, v100, v101
    v_cvt_pk_bf16_f32 v99, v102, v103
    ds_write_b128 v9, v[96:99] offset:3264
    s_mov_b64 exec, -1
    s_branch L_bendD
L_B3:
    s_and_b32 s61, s61, 127
    s_waitcnt lgkmcnt(0)
    v_and_b32 v22, 0xfffffe00, v2
    v_and_b32 v23, 0x1ff, v4
    v_add_u32 v9, s58, v7
    v_or_b32 v23, v23, v22
L_B3l:
    ds_read_b128 v[24:27], v23
    v_add_u32 v23, 256, v23
    s_waitcnt lgkmcnt(0)
    v_sub_u32 v34, v25, v24
    v_and_b32 v34, 0xff, v34
    v_add_u32 v32, v24, v10
    v_add_u32 v33, v25, v10
    v_sub_u32 v35, v33, v34
    v_add_u32 v34, v32, v34
    v_lshlrev_b32 v40, 16, v26
    v_and_b32 v41, 0xffff0000, v26
    v_lshlrev_b32 v42, 16, v27
    v_and_b32 v43, 0xffff0000, v27
    buffer_load_dwordx4 v[104:107], v32, s[4:7], 0 offen offset:0
    buffer_load_dwordx4 v[108:111], v33, s[4:7], 0 offen offset:0
    buffer_load_dwordx4 v[112:115], v34, s[4:7], 0 offen offset:0
    buffer_load_dwordx4 v[116:119], v35, s[4:7], 0 offen offset:0
    buffer_load_dwordx4 v[120:123], v32, s[4:7], 0 offen offset:64
    buffer_load_dwordx4 v[124:127], v33, s[4:7], 0 offen offset:64
    buffer_load_dwordx4 v[128:131], v34, s[4:7], 0 offen offset:64
    buffer_load_dwordx4 v[132:135], v35, s[4:7], 0 offen offset:64
    buffer_load_dwordx4 v[136:139], v32, s[4:7], 0 offen offset:128
    buffer_load_dwordx4 v[140:143], v33, s[4:7], 0 offen offset:128
    buffer_load_dwordx4 v[144:147], v34, s[4:7], 0 offen offset:128
    buffer_load_dwordx4 v[148:151], v35, s[4:7], 0 offen offset:128
    s_waitcnt vmcnt(11)
    v_lshlrev_b32 v46, 16, v104
    v_and_b32 v47, 0xffff0000, v104
    v_mul_f32 v80, v40, v46
    v_mul_f32 v81, v40, v47
    v_lshlrev_b32 v46, 16, v105
    v_and_b32 v47, 0xffff0000, v105
    v_mul_f32 v82, v40, v46
    v_mul_f32 v83, v40, v47
    v_lshlrev_b32 v46, 16, v106
    v_and_b32 v47, 0xffff0000, v106
    v_mul_f32 v84, v40, v46
    v_mul_f32 v85, v40, v47
    v_lshlrev_b32 v46, 16, v107
    v_and_b32 v47, 0xffff0000, v107
    v_mul_f32 v86, v40, v46
    v_mul_f32 v87, v40, v47
    s_waitcnt vmcnt(10)
    v_lshlrev_b32 v46, 16, v108
    v_and_b32 v47, 0xffff0000, v108
    v_fmac_f32 v80, v41, v46
    v_fmac_f32 v81, v41, v47
    v_lshlrev_b32 v46, 16, v109
    v_and_b32 v47, 0xffff0000, v109
    v_fmac_f32 v82, v41, v46
    v_fmac_f32 v83, v41, v47
    v_lshlrev_b32 v46, 16, v110
    v_and_b32 v47, 0xffff0000, v110
    v_fmac_f32 v84, v41, v46
    v_fmac_f32 v85, v41, v47
    v_lshlrev_b32 v46, 16, v111
    v_and_b32 v47, 0xffff0000, v111
    v_fmac_f32 v86, v41, v46
    v_fmac_f32 v87, v41, v47
    s_waitcnt vmcnt(9)
    v_lshlrev_b32 v46, 16, v112
    v_and_b32 v47, 0xffff0000, v112
    v_fmac_f32 v80, v42, v46
    v_fmac_f32 v81, v42, v47
    v_lshlrev_b32 v46, 16, v113
    v_and_b32 v47, 0xffff0000, v113
    v_fmac_f32 v82, v42, v46
    v_fmac_f32 v83, v42, v47
    v_lshlrev_b32 v46, 16, v114
    v_and_b32 v47, 0xffff0000, v114
    v_fmac_f32 v84, v42, v46
    v_fmac_f32 v85, v42, v47
    v_lshlrev_b32 v46, 16, v115
    v_and_b32 v47, 0xffff0000, v115
    v_fmac_f32 v86, v42, v46
    v_fmac_f32 v87, v42, v47
    s_waitcnt vmcnt(8)
    v_lshlrev_b32 v46, 16, v116
    v_and_b32 v47, 0xffff0000, v116
    v_fmac_f32 v80, v43, v46
    v_fmac_f32 v81, v43, v47
    v_lshlrev_b32 v46, 16, v117
    v_and_b32 v47, 0xffff0000, v117
    v_fmac_f32 v82, v43, v46
    v_fmac_f32 v83, v43, v47
    v_lshlrev_b32 v46, 16, v118
    v_and_b32 v47, 0xffff0000, v118
    v_fmac_f32 v84, v43, v46
    v_fmac_f32 v85, v43, v47
    v_lshlrev_b32 v46, 16, v119
    v_and_b32 v47, 0xffff0000, v119
    v_fmac_f32 v86, v43, v46
    v_fmac_f32 v87, v43, v47
    v_cvt_pk_bf16_f32 v56, v80, v81
    v_cvt_pk_bf16_f32 v57, v82, v83
    v_cvt_pk_bf16_f32 v58, v84, v85
    v_cvt_pk_bf16_f32 v59, v86, v87
    ds_write_b128 v9, v[56:59] offset:0
    s_waitcnt vmcnt(7)
    v_lshlrev_b32 v46, 16, v120
    v_and_b32 v47, 0xffff0000, v120
    v_mul_f32 v80, v40, v46
    v_mul_f32 v81, v40, v47
    v_lshlrev_b32 v46, 16, v121
    v_and_b32 v47, 0xffff0000, v121
    v_mul_f32 v82, v40, v46
    v_mul_f32 v83, v40, v47
    v_lshlrev_b32 v46, 16, v122
    v_and_b32 v47, 0xffff0000, v122
    v_mul_f32 v84, v40, v46
    v_mul_f32 v85, v40, v47
    v_lshlrev_b32 v46, 16, v123
    v_and_b32 v47, 0xffff0000, v123
    v_mul_f32 v86, v40, v46
    v_mul_f32 v87, v40, v47
    s_waitcnt vmcnt(6)
    v_lshlrev_b32 v46, 16, v124
    v_and_b32 v47, 0xffff0000, v124
    v_fmac_f32 v80, v41, v46
    v_fmac_f32 v81, v41, v47
    v_lshlrev_b32 v46, 16, v125
    v_and_b32 v47, 0xffff0000, v125
    v_fmac_f32 v82, v41, v46
    v_fmac_f32 v83, v41, v47
    v_lshlrev_b32 v46, 16, v126
    v_and_b32 v47, 0xffff0000, v126
    v_fmac_f32 v84, v41, v46
    v_fmac_f32 v85, v41, v47
    v_lshlrev_b32 v46, 16, v127
    v_and_b32 v47, 0xffff0000, v127
    v_fmac_f32 v86, v41, v46
    v_fmac_f32 v87, v41, v47
    s_waitcnt vmcnt(5)
    v_lshlrev_b32 v46, 16, v128
    v_and_b32 v47, 0xffff0000, v128
    v_fmac_f32 v80, v42, v46
    v_fmac_f32 v81, v42, v47
    v_lshlrev_b32 v46, 16, v129
    v_and_b32 v47, 0xffff0000, v129
    v_fmac_f32 v82, v42, v46
    v_fmac_f32 v83, v42, v47
    v_lshlrev_b32 v46, 16, v130
    v_and_b32 v47, 0xffff0000, v130
    v_fmac_f32 v84, v42, v46
    v_fmac_f32 v85, v42, v47
    v_lshlrev_b32 v46, 16, v131
    v_and_b32 v47, 0xffff0000, v131
    v_fmac_f32 v86, v42, v46
    v_fmac_f32 v87, v42, v47
    s_waitcnt vmcnt(4)
    v_lshlrev_b32 v46, 16, v132
    v_and_b32 v47, 0xffff0000, v132
    v_fmac_f32 v80, v43, v46
    v_fmac_f32 v81, v43, v47
    v_lshlrev_b32 v46, 16, v133
    v_and_b32 v47, 0xffff0000, v133
    v_fmac_f32 v82, v43, v46
    v_fmac_f32 v83, v43, v47
    v_lshlrev_b32 v46, 16, v134
    v_and_b32 v47, 0xffff0000, v134
    v_fmac_f32 v84, v43, v46
    v_fmac_f32 v85, v43, v47
    v_lshlrev_b32 v46, 16, v135
    v_and_b32 v47, 0xffff0000, v135
    v_fmac_f32 v86, v43, v46
    v_fmac_f32 v87, v43, v47
    v_cvt_pk_bf16_f32 v60, v80, v81
    v_cvt_pk_bf16_f32 v61, v82, v83
    v_cvt_pk_bf16_f32 v62, v84, v85
    v_cvt_pk_bf16_f32 v63, v86, v87
    ds_write_b128 v9, v[60:63] offset:64
    s_waitcnt vmcnt(3)
    v_lshlrev_b32 v46, 16, v136
    v_and_b32 v47, 0xffff0000, v136
    v_mul_f32 v80, v40, v46
    v_mul_f32 v81, v40, v47
    v_lshlrev_b32 v46, 16, v137
    v_and_b32 v47, 0xffff0000, v137
    v_mul_f32 v82, v40, v46
    v_mul_f32 v83, v40, v47
    v_lshlrev_b32 v46, 16, v138
    v_and_b32 v47, 0xffff0000, v138
    v_mul_f32 v84, v40, v46
    v_mul_f32 v85, v40, v47
    v_lshlrev_b32 v46, 16, v139
    v_and_b32 v47, 0xffff0000, v139
    v_mul_f32 v86, v40, v46
    v_mul_f32 v87, v40, v47
    s_waitcnt vmcnt(2)
    v_lshlrev_b32 v46, 16, v140
    v_and_b32 v47, 0xffff0000, v140
    v_fmac_f32 v80, v41, v46
    v_fmac_f32 v81, v41, v47
    v_lshlrev_b32 v46, 16, v141
    v_and_b32 v47, 0xffff0000, v141
    v_fmac_f32 v82, v41, v46
    v_fmac_f32 v83, v41, v47
    v_lshlrev_b32 v46, 16, v142
    v_and_b32 v47, 0xffff0000, v142
    v_fmac_f32 v84, v41, v46
    v_fmac_f32 v85, v41, v47
    v_lshlrev_b32 v46, 16, v143
    v_and_b32 v47, 0xffff0000, v143
    v_fmac_f32 v86, v41, v46
    v_fmac_f32 v87, v41, v47
    s_waitcnt vmcnt(1)
    v_lshlrev_b32 v46, 16, v144
    v_and_b32 v47, 0xffff0000, v144
    v_fmac_f32 v80, v42, v46
    v_fmac_f32 v81, v42, v47
    v_lshlrev_b32 v46, 16, v145
    v_and_b32 v47, 0xffff0000, v145
    v_fmac_f32 v82, v42, v46
    v_fmac_f32 v83, v42, v47
    v_lshlrev_b32 v46, 16, v146
    v_and_b32 v47, 0xffff0000, v146
    v_fmac_f32 v84, v42, v46
    v_fmac_f32 v85, v42, v47
    v_lshlrev_b32 v46, 16, v147
    v_and_b32 v47, 0xffff0000, v147
    v_fmac_f32 v86, v42, v46
    v_fmac_f32 v87, v42, v47
    s_waitcnt vmcnt(0)
    v_lshlrev_b32 v46, 16, v148
    v_and_b32 v47, 0xffff0000, v148
    v_fmac_f32 v80, v43, v46
    v_fmac_f32 v81, v43, v47
    v_lshlrev_b32 v46, 16, v149
    v_and_b32 v47, 0xffff0000, v149
    v_fmac_f32 v82, v43, v46
    v_fmac_f32 v83, v43, v47
    v_lshlrev_b32 v46, 16, v150
    v_and_b32 v47, 0xffff0000, v150
    v_fmac_f32 v84, v43, v46
    v_fmac_f32 v85, v43, v47
    v_lshlrev_b32 v46, 16, v151
    v_and_b32 v47, 0xffff0000, v151
    v_fmac_f32 v86, v43, v46
    v_fmac_f32 v87, v43, v47
    v_cvt_pk_bf16_f32 v64, v80, v81
    v_cvt_pk_bf16_f32 v65, v82, v83
    v_cvt_pk_bf16_f32 v66, v84, v85
    v_cvt_pk_bf16_f32 v67, v86, v87
    ds_write_b128 v9, v[64:67] offset:128
    v_add_u32 v9, 3136, v9
    s_mov_b64 exec, s[40:41]
    s_sub_i32 s61, s61, 16
    s_cmp_gt_i32 s61, 0
    s_cbranch_scc1 L_B3l
    s_mov_b64 exec, -1
    v_lshl_add_u32 v22, v0, 3, v22
    v_mov_b32 v32, 0
    v_mov_b32 v33, 0
    ds_write_b64 v22, v[32:33]
    s_branch L_bendS
.p2align 6
L_bab:
    s_barrier
    s_branch L_rst2
L_bs:
    v_lshrrev_b32 v38, 2, v0
    v_and_b32 v39, 3, v0
    v_bfe_u32 v28, v0, 2, 2
    v_add_u32 v29, -32, v29
    v_lshl_add_u32 v39, v39, 2, v28
    v_mov_b32 v28, 196
    s_mov_b32 s70, 0
    s_mov_b32 s66, 29
    s_mov_b32 s67, 0
    s_mov_b32 s61, 0
    s_mov_b32 s68, 0
    s_mov_b32 s69, 0
    s_mov_b32 s60, 0
    v_mov_b32 v37, 0
    v_mov_b32 v22, 0
    s_branch L_sg
L_bs2:
    s_waitcnt vmcnt(0)
    s_barrier
    ds_read_b32 v32, v30 offset:272
    ds_read_b32 v33, v29
    s_waitcnt lgkmcnt(0)
    v_readfirstlane_b32 s67, v32
    s_mul_i32 s67, s67, 196
    s_cmp_gt_u32 s67, s32
    v_readfirstlane_b32 s67, v33
    s_cbranch_scc1 L_bab
    s_bitcmp1_b32 s67, 0
    s_cbranch_scc0 L_bclean
    s_lshr_b32 s67, s67, 1
L_ss:
    ds_read_b32 v11, v1
    v_xor_b32 v1, 0x100, v1
    s_add_u32 s62, s62, 1
    s_min_u32 s62, s62, 31
    s_andn2_b32 s68, s67, 1
    v_add_u32 v22, s68, v38
    v_mad_u32_u24 v37, v22, v28, s34
    v_and_b32 v37, -16, v37
    ds_read_b128 v[24:27], v37
    s_waitcnt lgkmcnt(1)
    v_readfirstlane_b32 s60, v11
    s_bfe_u32 s61, s60, 0x80012
    s_cbranch_scc0 L_send
    s_add_u32 s69, s67, s61
L_sg:
    v_subrev_u32 v22, s67, v22
    v_add_u32 v23, s68, v39
    v_cmp_gt_u32 vcc, s61, v22
    v_mad_u32_u24 v9, v23, v28, s34
    v_subrev_u32 v23, s67, v23
    v_and_b32 v9, -16, v9
    v_cmp_gt_u32 s[72:73], s61, v23
    v_xor_b32 v9, v9, v10
    s_add_u32 s68, s68, 16
    s_waitcnt lgkmcnt(0)
    v_cndmask_b32 v24, 0, v24, vcc
    v_cndmask_b32 v25, 0, v25, vcc
    v_xor_b32 v32, v24, v5
    v_xor_b32 v33, v25, v5
    ds_read_b64_tr_b16 v[56:57], v32 offset:0
    ds_read_b64_tr_b16 v[58:59], v33 offset:0
    ds_read_b64_tr_b16 v[60:61], v32 offset:8
    ds_read_b64_tr_b16 v[62:63], v33 offset:8
    v_perm_b32 v40, v27, v26, v12
    ds_read_b64_tr_b16 v[64:65], v32 offset:64
    ds_read_b64_tr_b16 v[66:67], v33 offset:64
    v_perm_b32 v41, v27, v26, v13
    ds_read_b64_tr_b16 v[68:69], v32 offset:72
    ds_read_b64_tr_b16 v[70:71], v33 offset:72
    v_perm_b32 v42, v27, v26, v14
    ds_read_b64_tr_b16 v[72:73], v32 offset:128
    ds_read_b64_tr_b16 v[74:75], v33 offset:128
    v_perm_b32 v43, v27, v26, v15
    ds_read_b64_tr_b16 v[76:77], v32 offset:136
    ds_read_b64_tr_b16 v[78:79], v33 offset:136
    v_add_u32 v22, s68, v38
    v_add_u32 v37, 3136, v37
    ds_read_b128 v[24:27], v37 offset:0
    s_waitcnt lgkmcnt(11)
    v_mfma_f32_16x16x32_bf16 v[56:59], v[56:59], v[40:43], 0
    s_waitcnt lgkmcnt(9)
    v_mfma_f32_16x16x32_bf16 v[60:63], v[60:63], v[40:43], 0
    s_waitcnt lgkmcnt(7)
    v_mfma_f32_16x16x32_bf16 v[64:67], v[64:67], v[40:43], 0
    s_waitcnt lgkmcnt(5)
    v_mfma_f32_16x16x32_bf16 v[68:71], v[68:71], v[40:43], 0
    s_waitcnt lgkmcnt(3)
    v_mfma_f32_16x16x32_bf16 v[72:75], v[72:75], v[40:43], 0
    v_cvt_pk_bf16_f32 v56, v56, v57
    v_cvt_pk_bf16_f32 v57, v58, v59
    s_waitcnt lgkmcnt(1)
    v_mfma_f32_16x16x32_bf16 v[76:79], v[76:79], v[40:43], 0
    v_cvt_pk_bf16_f32 v58, v60, v61
    v_cvt_pk_bf16_f32 v59, v62, v63
    s_mov_b64 exec, s[72:73]
    ds_write_b128 v9, v[56:59] offset:0
    v_cvt_pk_bf16_f32 v64, v64, v65
    v_cvt_pk_bf16_f32 v65, v66, v67
    v_cvt_pk_bf16_f32 v66, v68, v69
    v_cvt_pk_bf16_f32 v67, v70, v71
    ds_write_b128 v9, v[64:67] offset:64
    v_cvt_pk_bf16_f32 v72, v72, v73
    v_cvt_pk_bf16_f32 v73, v74, v75
    v_cvt_pk_bf16_f32 v74, v76, v77
    v_cvt_pk_bf16_f32 v75, v78, v79
    ds_write_b128 v9, v[72:75] offset:128
    s_mov_b64 exec, -1
    s_cmp_lt_u32 s68, s69
    s_cbranch_scc1 L_sg
    s_mov_b32 s67, s69
L_send:
    s_or_b32 s70, s70, s60
    s_bitcmp1_b32 s66, s62
    s_cbranch_scc1 L_sw
    s_and_b32 s64, s70, 3
    s_cbranch_scc0 L_sb
    s_cmp_gt_u32 s62, 4
    s_cbranch_scc1 L_bexit
L_sb:
    s_waitcnt lgkmcnt(0)
    s_barrier
    s_branch L_ss
L_sw:
    s_cmp_eq_u32 s62, 2
    s_cbranch_scc1 L_sw2
    s_cmp_eq_u32 s62, 3
    s_cbranch_scc1 L_sw3
    s_cmp_eq_u32 s62, 0
    s_cbranch_scc1 L_bs2
    s_and_b32 s64, s70, 3
    s_cbranch_scc1 L_bexit
    s_waitcnt vmcnt(0) lgkmcnt(0)
    s_barrier
    s_branch L_ss
L_sw2:
    s_waitcnt lgkmcnt(0)
    s_add_u32 s50, s55, 43008
    s_sub_u32 s64, s35, s25
    s_sub_u32 s64, s64, 1
    s_min_u32 s64, s64, s30
    s_mul_i32 s64, s64, s28
    s_add_u32 m0, s64, s51
    s_add_u32 s54, s25, s30
    s_mul_i32 s54, s54, 43008
    s_mul_i32 s55, s30, s28
    s_add_u32 s55, s55, s51
    s_min_u32 s50, s50, s54
    s_mov_b64 exec, s[52:53]
    buffer_load_dwordx4 v20, s[4:7], s50 offen nt lds
    s_add_u32 m0, m0, s28
    s_add_u32 s50, s50, 43008
    s_min_u32 m0, m0, s55
    s_min_u32 s50, s50, s54
    buffer_load_dwordx4 v20, s[4:7], s50 offen nt lds
    s_add_u32 m0, m0, s28
    s_add_u32 s50, s50, 43008
    s_min_u32 m0, m0, s55
    s_min_u32 s50, s50, s54
    buffer_load_dwordx4 v20, s[4:7], s50 offen nt lds
    s_add_u32 m0, m0, s28
    s_add_u32 s50, s50, 43008
    s_min_u32 m0, m0, s55
    s_min_u32 s50, s50, s54
    buffer_load_dwordx4 v20, s[4:7], s50 offen nt lds
    s_mov_b64 exec, -1
    s_branch L_sb
L_sw3:
    s_waitcnt lgkmcnt(0)
    s_lshl_b32 s63, s21, 5
    s_add_u32 s63, s63, s39
    s_lshl_b32 s63, s63, 10
    s_add_u32 s63, s63, 131072
    buffer_load_dwordx4 v[16:19], v21, s[12:15], s63 offen
    s_add_u32 s63, s63, 131072
    buffer_load_dwordx4 v[16:19], v21, s[12:15], s63 offen
    s_add_u32 s63, s63, 131072
    buffer_load_dwordx4 v[16:19], v21, s[12:15], s63 offen
    s_branch L_sb
L_last:
    s_endpgm
.section .rodata,"a"
.p2align 6
.amdhsa_kernel standalone__deformable_dcnv1__vision_kernel
  .amdhsa_next_free_vgpr 168
  .amdhsa_next_free_sgpr 102
  .amdhsa_accum_offset 168
  .amdhsa_group_segment_fixed_size 0
  .amdhsa_kernarg_size 48
  .amdhsa_user_sgpr_count 2
  .amdhsa_user_sgpr_kernarg_segment_ptr 1
  .amdhsa_system_sgpr_workgroup_id_x 1
  .amdhsa_float_denorm_mode_32 3
.end_amdhsa_kernel
```
